```python
import torch

def _softmax(x, axis=-1):
    return torch.softmax(x, dim=axis)
def _gelu(x):
    return torch.nn.functional.gelu(x, approximate="tanh")
def _silu(x):
    return torch.nn.functional.silu(x)
def _sigmoid(x):
    return torch.sigmoid(x)
def _layernorm(x, axis=-1, eps=1e-5):
    m = x.mean(dim=axis, keepdim=True)
    v = x.var(dim=axis, keepdim=True, unbiased=False)
    return (x - m) / torch.sqrt(v + eps)
def _scatter_add(tgt, idx, src, axis=0):
    return tgt.clone().index_add_(axis, idx, src)
def _segment_sum(src, seg, n):
    out = torch.zeros((n,) + src.shape[1:], dtype=src.dtype)
    return out.index_add_(0, seg, src)
def _pad(x, pw):
    flat = tuple(v for pair in reversed(pw) for v in pair)
    return torch.nn.functional.pad(x, flat)

kernel_name = 'parallel_sum__mha_block_cached__geglu_ffn__decode'

def setup_inputs():

    _w = (lambda a: (lambda t: t.to(torch.bfloat16) if t.is_floating_point() else t)(torch.as_tensor(a)))
    def _A_setup():
        B, Sq, D = 2, 1, 576
        H, Sk, Dh = 32, 8192, 128
        return {
            "x": _w((lambda *s: torch.randn(*s, dtype=torch.bfloat16) * 0.05)(B, Sq, D)),
            "k_cache": _w((lambda *s: torch.randn(*s, dtype=torch.bfloat16) * 3.2)(B, H, Sk, Dh)),
            "v_cache": _w((lambda *s: torch.randn(*s, dtype=torch.bfloat16) * 1.6)(B, H, Sk, Dh)),
            "wq": _w((lambda *s: torch.randn(*s, dtype=torch.bfloat16) * 3.2)(D, H * Dh) * (D ** -0.5)),
            "wo": _w((lambda *s: torch.randn(*s, dtype=torch.bfloat16) * 1.6)(H * Dh, D) * ((H * Dh) ** -0.5)),
        }
    _A_in = _A_setup()

    def _B_setup():
        B, S, D, F = 2, 1, 576, 4608
        return {
            "x": _w((lambda *s: torch.randn(*s, dtype=torch.bfloat16) * 0.05)(B, S, D)),
            "w_gate": _w((lambda *s: torch.randn(*s, dtype=torch.bfloat16) * 0.05)(D, F)),
            "w_up": _w((lambda *s: torch.randn(*s, dtype=torch.bfloat16) * 0.05)(D, F)),
            "w_down": _w((lambda *s: torch.randn(*s, dtype=torch.bfloat16) * 0.05)(F, D)),
        }
    _B_in = _B_setup()

    return {
        "A_x": _A_in["x"],
        "A_k_cache": _A_in["k_cache"],
        "A_v_cache": _A_in["v_cache"],
        "A_wq": _A_in["wq"],
        "A_wo": _A_in["wo"],
        "B_x": _B_in["x"],
        "B_w_gate": _B_in["w_gate"],
        "B_w_up": _B_in["w_up"],
        "B_w_down": _B_in["w_down"],
    }

def reference(A_x, A_k_cache, A_v_cache, A_wq, A_wo, B_x, B_w_gate, B_w_up, B_w_down):
    def _A_ref(x, k_cache, v_cache, wq, wo):
        B, Sq, D = x.shape
        H, Dh = 32, 128
        q = (lambda x, *d: x.permute(*d))((x @ wq).reshape(B, Sq, H, Dh), 0, 2, 1, 3)
        scores = torch.einsum("bhqd,bhkd->bhqk", q, k_cache) * (Dh ** -0.5)
        p = _softmax(scores, axis=-1)
        o = torch.einsum("bhqk,bhkd->bhqd", p, v_cache)
        return (lambda x, *d: x.permute(*d))(o, 0, 2, 1, 3).reshape(B, Sq, H * Dh) @ wo

    def _B_ref(x, w_gate, w_up, w_down):
        return (_gelu(x @ w_gate) * (x @ w_up)) @ w_down

    x = A_x
    xn = _layernorm(x, axis=-1)
    return x + _A_ref(xn, A_k_cache, A_v_cache, A_wq, A_wo) + _B_ref(xn, B_w_gate, B_w_up, B_w_down)
```

```asm
; @launch grid=(256,1,1) block=(576,1,1) lds=59392
.amdgcn_target "amdgcn-amd-amdhsa--gfx950"
.text
.globl parallel_sum__mha_block_cached__geglu_ffn__decode_kernel
.p2align 8
.type parallel_sum__mha_block_cached__geglu_ffn__decode_kernel,@function
parallel_sum__mha_block_cached__geglu_ffn__decode_kernel:
  s_cmp_ge_u32 s2, 256
  s_cbranch_scc1 L_end
  s_load_dwordx16 s[4:19], s[0:1], 0
  s_load_dwordx8 s[20:27], s[0:1], 64
  v_lshrrev_b32 v1, 6, v0
  v_and_b32 v0, 63, v0
  s_and_b32 s52, s2, 31
  v_readfirstlane_b32 s3, v1
  s_bfe_u32 s53, s2, 0x10005
  s_lshr_b32 s54, s2, 6
  s_lshl_b32 s55, s53, 5
  s_add_u32 s55, s55, s52
  s_lshl_b32 s60, s55, 2
  s_add_u32 s60, s60, s54
  s_mov_b32 s59, 0
  s_lshr_b32 s84, s2, 1
  s_and_b32 s88, s60, 127
  s_mul_i32 s88, s88, 36
  s_waitcnt lgkmcnt(0)
  s_mov_b32 s44, s26
  s_mov_b32 s45, s27
  s_mov_b32 s46, 0x00340000
  s_mov_b32 s47, 0x20000
  s_cmp_eq_u32 s3, 8
  s_cbranch_scc1 L_aux
  s_min_u32 s84, s84, 103
  s_cmp_lt_u32 s84, 68
  s_cselect_b64 s[36:37], s[16:17], s[18:19]
  s_cselect_b32 s56, 32, 68
  s_cmp_lt_u32 s84, 32
  s_cselect_b64 s[36:37], s[10:11], s[36:37]
  s_cselect_b32 s56, 0, s56
  s_cselect_b32 s61, 8, 9
  s_lshl_b32 s61, s61, 10
  s_mul_i32 s38, s61, 576
  s_cmp_lt_u32 s2, 208
  s_cselect_b32 s38, s38, 0
  s_mov_b32 s39, 0x20000
  s_sub_u32 s56, s84, s56
  s_lshl_b32 s56, s56, 8
  s_and_b32 s85, s2, 1
  s_mul_i32 s85, s85, 288
  s_mul_i32 s58, s3, 36
  s_add_u32 s85, s85, s58
  s_mul_i32 s58, s85, s61
  s_add_u32 s86, s56, s58
  s_mov_b32 s40, s4
  s_mov_b32 s41, s5
  s_mov_b32 s42, 0x00000900
  s_mov_b32 s43, 0x20000
  v_mul_u32_u24 v10, 36, v0
  buffer_load_dwordx4 v[160:163], v10, s[40:43], 0 offen
  buffer_load_dwordx4 v[156:159], v10, s[40:43], 0 offen offset:16
  buffer_load_dword v152, v10, s[40:43], 0 offen offset:32
  v_lshrrev_b32 v10, 5, v0
  v_mul_u32_u24 v10, 1152, v10
  v_and_b32 v11, 31, v0
  v_lshl_add_u32 v10, v11, 2, v10
  s_lshl_b32 s58, s85, 1
  v_add_u32 v11, s58, v10
  buffer_load_dword v153, v11, s[40:43], 0 offen
  v_lshrrev_b32 v165, 4, v0
  v_mul_lo_u32 v165, v165, s61
  v_and_b32 v167, 15, v0
  v_lshl_add_u32 v165, v167, 4, v165
  s_lshl_b32 s61, s61, 2
  buffer_load_dwordx4 v[128:131], v165, s[36:39], s86 offen
  s_add_u32 s86, s86, s61
  buffer_load_dwordx4 v[124:127], v165, s[36:39], s86 offen
  s_add_u32 s86, s86, s61
  buffer_load_dwordx4 v[120:123], v165, s[36:39], s86 offen
  s_add_u32 s86, s86, s61
  buffer_load_dwordx4 v[116:119], v165, s[36:39], s86 offen
  s_add_u32 s86, s86, s61
  buffer_load_dwordx4 v[112:115], v165, s[36:39], s86 offen
  s_add_u32 s86, s86, s61
  buffer_load_dwordx4 v[108:111], v165, s[36:39], s86 offen
  s_add_u32 s86, s86, s61
  buffer_load_dwordx4 v[104:107], v165, s[36:39], s86 offen
  s_add_u32 s86, s86, s61
  buffer_load_dwordx4 v[100:103], v165, s[36:39], s86 offen
  s_add_u32 s86, s86, s61
  buffer_load_dwordx4 v[96:99], v165, s[36:39], s86 offen
  s_mov_b32 s28, s6
  s_mov_b32 s29, s7
  s_mov_b32 s30, 0x08000000
  s_mov_b32 s31, 0x20000
  v_lshlrev_b32 v1, 4, v0
  s_lshl_b32 s57, s55, 21
  s_lshl_b32 s56, s54, 15
  s_add_u32 s57, s57, s56
  s_lshl_b32 s56, s3, 12
  s_add_u32 s57, s57, s56
  s_add_u32 s58, s57, 0
  buffer_load_dwordx4 v[24:27], v1, s[28:31], s58 offen offset:0 nt
  s_barrier
  s_mov_b32 s32, s8
  s_mov_b32 s33, s9
  s_mov_b32 s34, 0x08000000
  s_mov_b32 s35, 0x20000
  s_mov_b32 s48, s12
  s_mov_b32 s49, s13
  s_mov_b32 s50, 0x00480000
  s_mov_b32 s51, 0x20000
  v_and_b32 v10, 1, v0
  v_lshlrev_b32 v10, 4, v10
  v_mov_b32 v11, 0xffff
  v_lshlrev_b32 v11, v10, v11
  v_bfe_u32 v10, v0, 1, 2
  v_cmp_eq_u32 vcc, 0, v10
  s_nop 1
  v_cndmask_b32 v2, 0, v11, vcc
  v_cmp_eq_u32 vcc, 1, v10
  s_nop 1
  v_cndmask_b32 v3, 0, v11, vcc
  v_cmp_eq_u32 vcc, 2, v10
  s_nop 1
  v_cndmask_b32 v4, 0, v11, vcc
  v_cmp_eq_u32 vcc, 3, v10
  s_nop 1
  v_cndmask_b32 v5, 0, v11, vcc
  s_waitcnt vmcnt(10)
  v_lshlrev_b32 v154, 16, v160
  v_and_b32 v155, 0xffff0000, v160
  v_lshlrev_b32 v148, 16, v161
  v_and_b32 v149, 0xffff0000, v161
  v_lshlrev_b32 v150, 16, v162
  v_and_b32 v151, 0xffff0000, v162
  v_lshlrev_b32 v144, 16, v163
  v_and_b32 v145, 0xffff0000, v163
  v_lshlrev_b32 v146, 16, v156
  v_and_b32 v147, 0xffff0000, v156
  v_lshlrev_b32 v140, 16, v157
  v_and_b32 v141, 0xffff0000, v157
  v_lshlrev_b32 v142, 16, v158
  v_and_b32 v143, 0xffff0000, v158
  v_lshlrev_b32 v136, 16, v159
  v_and_b32 v137, 0xffff0000, v159
  v_lshlrev_b32 v138, 16, v152
  v_and_b32 v139, 0xffff0000, v152
  v_add_f32 v12, v154, v155
  v_add_f32 v13, v148, v149
  v_add_f32 v12, v12, v150
  v_add_f32 v13, v13, v151
  v_add_f32 v12, v12, v144
  v_add_f32 v13, v13, v145
  v_add_f32 v12, v12, v146
  v_add_f32 v13, v13, v147
  v_add_f32 v12, v12, v140
  v_add_f32 v13, v13, v141
  v_add_f32 v12, v12, v142
  v_add_f32 v13, v13, v143
  v_add_f32 v12, v12, v136
  v_add_f32 v13, v13, v137
  v_add_f32 v12, v12, v138
  v_add_f32 v13, v13, v139
  v_add_f32 v12, v12, v13
  s_nop 1
  v_add_f32_dpp v12, v12, v12 row_ror:8 row_mask:0xf bank_mask:0xf
  s_nop 1
  v_add_f32_dpp v12, v12, v12 row_ror:4 row_mask:0xf bank_mask:0xf
  s_nop 1
  v_add_f32_dpp v12, v12, v12 row_ror:2 row_mask:0xf bank_mask:0xf
  s_nop 1
  v_add_f32_dpp v12, v12, v12 row_ror:1 row_mask:0xf bank_mask:0xf
  v_mov_b32 v10, v12
  s_nop 1
  v_permlane16_swap_b32 v12, v10
  s_nop 1
  v_add_f32 v12, v12, v10
  v_mul_f32 v12, 0x3ae38e39, v12
  v_sub_f32 v154, v154, v12
  v_sub_f32 v155, v155, v12
  v_sub_f32 v148, v148, v12
  v_sub_f32 v149, v149, v12
  v_sub_f32 v150, v150, v12
  v_sub_f32 v151, v151, v12
  v_sub_f32 v144, v144, v12
  v_sub_f32 v145, v145, v12
  v_sub_f32 v146, v146, v12
  v_sub_f32 v147, v147, v12
  v_sub_f32 v140, v140, v12
  v_sub_f32 v141, v141, v12
  v_sub_f32 v142, v142, v12
  v_sub_f32 v143, v143, v12
  v_sub_f32 v136, v136, v12
  v_sub_f32 v137, v137, v12
  v_sub_f32 v138, v138, v12
  v_sub_f32 v139, v139, v12
  v_mul_f32 v13, v154, v154
  v_mul_f32 v14, v155, v155
  v_fmac_f32 v13, v148, v148
  v_fmac_f32 v14, v149, v149
  v_fmac_f32 v13, v150, v150
  v_fmac_f32 v14, v151, v151
  v_fmac_f32 v13, v144, v144
  v_fmac_f32 v14, v145, v145
  v_fmac_f32 v13, v146, v146
  v_fmac_f32 v14, v147, v147
  v_fmac_f32 v13, v140, v140
  v_fmac_f32 v14, v141, v141
  v_fmac_f32 v13, v142, v142
  v_fmac_f32 v14, v143, v143
  v_fmac_f32 v13, v136, v136
  v_fmac_f32 v14, v137, v137
  v_fmac_f32 v13, v138, v138
  v_fmac_f32 v14, v139, v139
  v_add_f32 v13, v13, v14
  s_nop 1
  v_add_f32_dpp v13, v13, v13 row_ror:8 row_mask:0xf bank_mask:0xf
  s_nop 1
  v_add_f32_dpp v13, v13, v13 row_ror:4 row_mask:0xf bank_mask:0xf
  s_nop 1
  v_add_f32_dpp v13, v13, v13 row_ror:2 row_mask:0xf bank_mask:0xf
  s_nop 1
  v_add_f32_dpp v13, v13, v13 row_ror:1 row_mask:0xf bank_mask:0xf
  v_mov_b32 v10, v13
  s_nop 1
  v_permlane16_swap_b32 v13, v10
  s_nop 1
  v_add_f32 v13, v13, v10
  v_mul_f32 v13, 0x3ae38e39, v13
  v_cvt_pk_bf16_f32 v13, v13, v13
  v_and_b32 v13, 0xffff0000, v13
  v_add_f32 v13, 0x3727c5ac, v13
  v_cvt_pk_bf16_f32 v13, v13, v13
  v_and_b32 v13, 0xffff0000, v13
  v_sqrt_f32 v13, v13
  s_nop 0
  v_cvt_pk_bf16_f32 v13, v13, v13
  v_and_b32 v13, 0xffff0000, v13
  v_rcp_f32 v14, v13
  v_cvt_pk_bf16_f32 v12, v12, v12
  v_and_b32 v12, 0xffff0000, v12
  v_lshlrev_b32 v16, 16, v153
  v_and_b32 v17, 0xffff0000, v153
  v_sub_f32 v16, v16, v12
  v_cvt_pk_bf16_f32 v16, v16, v16
  v_and_b32 v16, 0xffff0000, v16
  v_mul_f32 v10, v16, v14
  v_fma_f32 v11, -v10, v13, v16
  v_fma_f32 v10, v11, v14, v10
  v_cvt_pk_bf16_f32 v18, v10, v10
  v_sub_f32 v17, v17, v12
  v_cvt_pk_bf16_f32 v17, v17, v17
  v_and_b32 v17, 0xffff0000, v17
  v_mul_f32 v10, v17, v14
  v_fma_f32 v11, -v10, v13, v17
  v_fma_f32 v10, v11, v14, v10
  v_cvt_pk_bf16_f32 v19, v10, v10
  s_lshl_b32 s56, s3, 9
  v_lshrrev_b32 v10, 5, v0
  v_lshlrev_b32 v10, 8, v10
  v_and_b32 v11, 1, v0
  v_lshl_add_u32 v10, v11, 7, v10
  v_bfe_u32 v11, v0, 1, 4
  v_lshl_add_u32 v10, v11, 2, v10
  v_add_u32 v10, s56, v10
  ds_write_b32 v10, v18 offset:0
  ds_write_b32 v10, v19 offset:64
  v_bfe_u32 v10, v0, 3, 1
  v_lshlrev_b32 v10, 8, v10
  v_lshrrev_b32 v11, 4, v0
  v_lshl_add_u32 v10, v11, 6, v10
  v_add_u32 v10, s56, v10
  s_waitcnt lgkmcnt(0)
  ds_read_b128 v[148:151], v10 offset:0
  ds_read_b128 v[144:147], v10 offset:16
  ds_read_b32 v140, v10 offset:32
  v_mov_b32 v12, 0
  v_mov_b32 v13, 0
  v_mov_b32 v14, 0
  v_mov_b32 v15, 0
  v_and_b32 v166, 15, v0
  v_lshlrev_b32 v166, 5, v166
  v_and_b32 v11, 16, v0
  v_add_u32 v166, v166, v11
  v_lshrrev_b32 v11, 5, v0
  v_lshl_add_u32 v10, v11, 9, v166
  s_lshl_b32 s56, s3, 10
  v_add_u32 v10, s56, v10
  v_mul_u32_u24 v11, 2560, v11
  v_add_u32 v166, v166, v11
  s_waitcnt lgkmcnt(0)
  v_and_b32 v16, v148, v2
  v_and_b32 v17, v148, v3
  v_and_b32 v18, v148, v4
  v_and_b32 v19, v148, v5
  s_waitcnt vmcnt(9)
  s_nop 0
  v_mfma_f32_16x16x32_bf16 v[12:15], v[16:19], v[128:131], v[12:15]
  v_and_b32 v20, v149, v2
  v_and_b32 v21, v149, v3
  v_and_b32 v22, v149, v4
  v_and_b32 v23, v149, v5
  s_waitcnt vmcnt(8)
  s_nop 0
  v_mfma_f32_16x16x32_bf16 v[12:15], v[20:23], v[124:127], v[12:15]
  v_and_b32 v16, v150, v2
  v_and_b32 v17, v150, v3
  v_and_b32 v18, v150, v4
  v_and_b32 v19, v150, v5
  s_waitcnt vmcnt(7)
  s_nop 0
  v_mfma_f32_16x16x32_bf16 v[12:15], v[16:19], v[120:123], v[12:15]
  v_and_b32 v20, v151, v2
  v_and_b32 v21, v151, v3
  v_and_b32 v22, v151, v4
  v_and_b32 v23, v151, v5
  s_waitcnt vmcnt(6)
  s_nop 0
  v_mfma_f32_16x16x32_bf16 v[12:15], v[20:23], v[116:119], v[12:15]
  v_and_b32 v16, v144, v2
  v_and_b32 v17, v144, v3
  v_and_b32 v18, v144, v4
  v_and_b32 v19, v144, v5
  s_waitcnt vmcnt(5)
  s_nop 0
  v_mfma_f32_16x16x32_bf16 v[12:15], v[16:19], v[112:115], v[12:15]
  v_and_b32 v20, v145, v2
  v_and_b32 v21, v145, v3
  v_and_b32 v22, v145, v4
  v_and_b32 v23, v145, v5
  s_waitcnt vmcnt(4)
  s_nop 0
  v_mfma_f32_16x16x32_bf16 v[12:15], v[20:23], v[108:111], v[12:15]
  v_and_b32 v16, v146, v2
  v_and_b32 v17, v146, v3
  v_and_b32 v18, v146, v4
  v_and_b32 v19, v146, v5
  s_waitcnt vmcnt(3)
  s_nop 0
  v_mfma_f32_16x16x32_bf16 v[12:15], v[16:19], v[104:107], v[12:15]
  v_and_b32 v20, v147, v2
  v_and_b32 v21, v147, v3
  v_and_b32 v22, v147, v4
  v_and_b32 v23, v147, v5
  s_waitcnt vmcnt(2)
  s_nop 0
  v_mfma_f32_16x16x32_bf16 v[12:15], v[20:23], v[100:103], v[12:15]
  v_and_b32 v16, v140, v2
  v_and_b32 v17, v140, v3
  v_and_b32 v18, v140, v4
  v_and_b32 v19, v140, v5
  s_waitcnt vmcnt(1)
  s_nop 0
  v_mfma_f32_16x16x32_bf16 v[12:15], v[16:19], v[96:99], v[12:15]
  v_mov_b32 v11, 1
  v_mov_b32 v16, 0
  s_nop 5
  ds_write_b128 v10, v[12:15] offset:4096
  s_waitcnt lgkmcnt(0)
  s_mov_b64 exec, 1
  ds_add_u32 v16, v11 offset:13056
  s_mov_b64 exec, -1
  v_lshrrev_b32 v11, 4, v0
  v_mul_u32_u24 v11, 1152, v11
  v_and_b32 v10, 15, v0
  v_lshlrev_b32 v10, 4, v10
  v_add_u32 v165, v11, v10
  s_lshl_b32 s56, s52, 7
  s_lshl_b32 s58, s3, 4
  s_add_u32 s56, s56, s58
  s_mul_i32 s56, s56, 1152
  v_add_u32 v167, s56, v165
  s_mov_b32 s36, s20
  s_mov_b32 s37, s21
  s_mov_b32 s38, 0x00510000
  s_mov_b32 s39, 0x20000
  s_lshl_b32 s56, s3, 2
  s_add_u32 s56, s56, s88
  s_mul_i32 s86, s56, 1152
  s_sub_u32 s86, s86, 0
  v_readfirstlane_b32 s84, v167
  v_mov_b32 v164, 0xff800000
  s_add_u32 s58, s57, 0
  buffer_load_dwordx4 v[28:31], v1, s[28:31], s58 offen offset:1024 nt
  s_add_u32 s58, s57, 0
  buffer_load_dwordx4 v[32:35], v1, s[28:31], s58 offen offset:2048 nt
  s_waitcnt vmcnt(2)
  s_add_u32 s58, s57, 0
  buffer_load_dwordx4 v[36:39], v1, s[28:31], s58 offen offset:3072 nt
  s_waitcnt vmcnt(2)
  s_add_u32 s58, s57, 131072
  buffer_load_dwordx4 v[40:43], v1, s[28:31], s58 offen offset:0 nt
  s_waitcnt vmcnt(2)
  s_add_u32 s58, s57, 131072
  buffer_load_dwordx4 v[44:47], v1, s[28:31], s58 offen offset:1024 nt
  s_waitcnt vmcnt(2)
  s_add_u32 s58, s57, 131072
  buffer_load_dwordx4 v[48:51], v1, s[28:31], s58 offen offset:2048 nt
  s_waitcnt vmcnt(2)
  s_add_u32 s58, s57, 131072
  buffer_load_dwordx4 v[52:55], v1, s[28:31], s58 offen offset:3072 nt
  s_waitcnt vmcnt(2)
  s_add_u32 s58, s57, 262144
  buffer_load_dwordx4 v[56:59], v1, s[28:31], s58 offen offset:0 nt
  s_waitcnt vmcnt(2)
  s_add_u32 s58, s57, 262144
  buffer_load_dwordx4 v[60:63], v1, s[28:31], s58 offen offset:1024 nt
  s_waitcnt vmcnt(2)
  s_add_u32 s58, s57, 262144
  buffer_load_dwordx4 v[64:67], v1, s[28:31], s58 offen offset:2048 nt
  s_waitcnt vmcnt(2)
  s_add_u32 s58, s57, 262144
  buffer_load_dwordx4 v[68:71], v1, s[28:31], s58 offen offset:3072 nt
  s_waitcnt vmcnt(2)
  s_add_u32 s58, s57, 393216
  buffer_load_dwordx4 v[72:75], v1, s[28:31], s58 offen offset:0 nt
  s_waitcnt vmcnt(2)
  s_add_u32 s58, s57, 393216
  buffer_load_dwordx4 v[76:79], v1, s[28:31], s58 offen offset:1024 nt
  s_waitcnt vmcnt(2)
  s_add_u32 s58, s57, 393216
  buffer_load_dwordx4 v[80:83], v1, s[28:31], s58 offen offset:2048 nt
  s_waitcnt vmcnt(2)
  s_add_u32 s58, s57, 393216
  buffer_load_dwordx4 v[84:87], v1, s[28:31], s58 offen offset:3072 nt
  s_waitcnt vmcnt(2)
  s_add_u32 s58, s57, 524288
  buffer_load_dwordx4 v[88:91], v1, s[28:31], s58 offen offset:0 nt
  s_waitcnt vmcnt(2)
  s_add_u32 s58, s57, 524288
  buffer_load_dwordx4 v[92:95], v1, s[28:31], s58 offen offset:1024 nt
  s_waitcnt vmcnt(2)
  s_add_u32 s58, s57, 524288
  buffer_load_dwordx4 v[160:163], v1, s[28:31], s58 offen offset:2048 nt
  s_waitcnt vmcnt(2)
  s_add_u32 s58, s57, 524288
  buffer_load_dwordx4 v[156:159], v1, s[28:31], s58 offen offset:3072 nt
  s_waitcnt vmcnt(2)
  s_add_u32 s58, s57, 655360
  buffer_load_dwordx4 v[152:155], v1, s[28:31], s58 offen offset:0 nt
  s_waitcnt vmcnt(2)
  s_add_u32 s58, s57, 655360
  buffer_load_dwordx4 v[136:139], v1, s[28:31], s58 offen offset:1024 nt
  s_waitcnt vmcnt(2)
  s_add_u32 s58, s57, 655360
  buffer_load_dwordx4 v[132:135], v1, s[28:31], s58 offen offset:2048 nt
  s_waitcnt vmcnt(2)
  s_add_u32 s58, s57, 655360
  buffer_load_dwordx4 v[128:131], v1, s[28:31], s58 offen offset:3072 nt
  s_waitcnt vmcnt(2)
  s_add_u32 s58, s57, 786432
  buffer_load_dwordx4 v[124:127], v1, s[28:31], s58 offen offset:0 nt
  s_waitcnt vmcnt(2)
  s_add_u32 s58, s57, 786432
  buffer_load_dwordx4 v[120:123], v1, s[28:31], s58 offen offset:1024 nt
L_qw_1:
  ds_read_b32 v11, v16 offset:13060
  s_waitcnt lgkmcnt(0)
  v_cmp_eq_u32 vcc, 0, v11
  s_cbranch_vccz L_qok_2
  s_add_u32 s59, s59, 1
  s_cmp_gt_u32 s59, 4000000
  s_cbranch_scc1 L_qok_2
  s_sleep 2
  s_branch L_qw_1
L_qok_2:
  s_mov_b32 s59, 0
  ds_read_b128 v[6:9], v10 offset:12288
  ds_read_b32 v11, v16 offset:12544
  s_waitcnt lgkmcnt(0)
  v_readfirstlane_b32 s87, v11
  v_dot2_f32_bf16 v16, v24, v6, 0
  v_dot2_f32_bf16 v17, v28, v6, 0
  v_dot2_f32_bf16 v18, v32, v6, 0
  v_dot2_f32_bf16 v19, v36, v6, 0
  v_dot2c_f32_bf16 v16, v25, v7
  v_dot2c_f32_bf16 v17, v29, v7
  v_dot2c_f32_bf16 v18, v33, v7
  v_dot2c_f32_bf16 v19, v37, v7
  v_dot2c_f32_bf16 v16, v26, v8
  v_dot2c_f32_bf16 v17, v30, v8
  v_dot2c_f32_bf16 v18, v34, v8
  v_dot2c_f32_bf16 v19, v38, v8
  v_dot2c_f32_bf16 v16, v27, v9
  v_dot2c_f32_bf16 v17, v31, v9
  v_dot2c_f32_bf16 v18, v35, v9
  v_dot2c_f32_bf16 v19, v39, v9
  s_nop 2
  v_add_f32_dpp v16, v16, v16 row_ror:8 row_mask:0xf bank_mask:0x3
  v_add_f32_dpp v16, v18, v18 row_ror:8 row_mask:0xf bank_mask:0xc
  v_add_f32_dpp v17, v17, v17 row_ror:8 row_mask:0xf bank_mask:0x3
  v_add_f32_dpp v17, v19, v19 row_ror:8 row_mask:0xf bank_mask:0xc
  s_nop 0
  v_add_f32_dpp v16, v16, v16 row_shl:4 row_mask:0xf bank_mask:0x5
  s_nop 0
  v_add_f32_dpp v16, v17, v17 row_shr:4 row_mask:0xf bank_mask:0xa
  s_nop 1
  v_add_f32_dpp v16, v16, v16 quad_perm:[1,0,3,2] row_mask:0xf bank_mask:0xf
  s_nop 1
  v_add_f32_dpp v16, v16, v16 quad_perm:[2,3,0,1] row_mask:0xf bank_mask:0xf
  v_cvt_pk_bf16_f32 v16, v16, v16
  v_and_b32 v16, 0xffff0000, v16
  v_mul_f32 v16, 0x3db504f3, v16
  v_cvt_pk_bf16_f32 v24, v16, v16
  v_and_b32 v24, 0xffff0000, v24
  v_max_f32 v164, v164, v24
  v_dot2_f32_bf16 v16, v40, v6, 0
  v_dot2_f32_bf16 v17, v44, v6, 0
  v_dot2_f32_bf16 v18, v48, v6, 0
  v_dot2_f32_bf16 v19, v52, v6, 0
  v_dot2c_f32_bf16 v16, v41, v7
  v_dot2c_f32_bf16 v17, v45, v7
  v_dot2c_f32_bf16 v18, v49, v7
  v_dot2c_f32_bf16 v19, v53, v7
  v_dot2c_f32_bf16 v16, v42, v8
  v_dot2c_f32_bf16 v17, v46, v8
  v_dot2c_f32_bf16 v18, v50, v8
  v_dot2c_f32_bf16 v19, v54, v8
  v_dot2c_f32_bf16 v16, v43, v9
  v_dot2c_f32_bf16 v17, v47, v9
  v_dot2c_f32_bf16 v18, v51, v9
  v_dot2c_f32_bf16 v19, v55, v9
  s_nop 2
  v_add_f32_dpp v16, v16, v16 row_ror:8 row_mask:0xf bank_mask:0x3
  v_add_f32_dpp v16, v18, v18 row_ror:8 row_mask:0xf bank_mask:0xc
  v_add_f32_dpp v17, v17, v17 row_ror:8 row_mask:0xf bank_mask:0x3
  v_add_f32_dpp v17, v19, v19 row_ror:8 row_mask:0xf bank_mask:0xc
  s_nop 0
  v_add_f32_dpp v16, v16, v16 row_shl:4 row_mask:0xf bank_mask:0x5
  s_nop 0
  v_add_f32_dpp v16, v17, v17 row_shr:4 row_mask:0xf bank_mask:0xa
  s_nop 1
  v_add_f32_dpp v16, v16, v16 quad_perm:[1,0,3,2] row_mask:0xf bank_mask:0xf
  s_nop 1
  v_add_f32_dpp v16, v16, v16 quad_perm:[2,3,0,1] row_mask:0xf bank_mask:0xf
  v_cvt_pk_bf16_f32 v16, v16, v16
  v_and_b32 v16, 0xffff0000, v16
  v_mul_f32 v16, 0x3db504f3, v16
  v_cvt_pk_bf16_f32 v25, v16, v16
  v_and_b32 v25, 0xffff0000, v25
  v_max_f32 v164, v164, v25
  s_waitcnt vmcnt(2)
  s_add_u32 s58, s57, 786432
  buffer_load_dwordx4 v[116:119], v1, s[28:31], s58 offen offset:2048 nt
  v_dot2_f32_bf16 v16, v56, v6, 0
  v_dot2_f32_bf16 v17, v60, v6, 0
  v_dot2_f32_bf16 v18, v64, v6, 0
  v_dot2_f32_bf16 v19, v68, v6, 0
  v_dot2c_f32_bf16 v16, v57, v7
  v_dot2c_f32_bf16 v17, v61, v7
  v_dot2c_f32_bf16 v18, v65, v7
  v_dot2c_f32_bf16 v19, v69, v7
  v_dot2c_f32_bf16 v16, v58, v8
  v_dot2c_f32_bf16 v17, v62, v8
  v_dot2c_f32_bf16 v18, v66, v8
  v_dot2c_f32_bf16 v19, v70, v8
  v_dot2c_f32_bf16 v16, v59, v9
  v_dot2c_f32_bf16 v17, v63, v9
  v_dot2c_f32_bf16 v18, v67, v9
  v_dot2c_f32_bf16 v19, v71, v9
  s_nop 2
  v_add_f32_dpp v16, v16, v16 row_ror:8 row_mask:0xf bank_mask:0x3
  v_add_f32_dpp v16, v18, v18 row_ror:8 row_mask:0xf bank_mask:0xc
  v_add_f32_dpp v17, v17, v17 row_ror:8 row_mask:0xf bank_mask:0x3
  v_add_f32_dpp v17, v19, v19 row_ror:8 row_mask:0xf bank_mask:0xc
  s_nop 0
  v_add_f32_dpp v16, v16, v16 row_shl:4 row_mask:0xf bank_mask:0x5
  s_nop 0
  v_add_f32_dpp v16, v17, v17 row_shr:4 row_mask:0xf bank_mask:0xa
  s_nop 1
  v_add_f32_dpp v16, v16, v16 quad_perm:[1,0,3,2] row_mask:0xf bank_mask:0xf
  s_nop 1
  v_add_f32_dpp v16, v16, v16 quad_perm:[2,3,0,1] row_mask:0xf bank_mask:0xf
  v_cvt_pk_bf16_f32 v16, v16, v16
  v_and_b32 v16, 0xffff0000, v16
  v_mul_f32 v16, 0x3db504f3, v16
  v_cvt_pk_bf16_f32 v26, v16, v16
  v_and_b32 v26, 0xffff0000, v26
  v_max_f32 v164, v164, v26
  v_dot2_f32_bf16 v16, v72, v6, 0
  v_dot2_f32_bf16 v17, v76, v6, 0
  v_dot2_f32_bf16 v18, v80, v6, 0
  v_dot2_f32_bf16 v19, v84, v6, 0
  v_dot2c_f32_bf16 v16, v73, v7
  v_dot2c_f32_bf16 v17, v77, v7
  v_dot2c_f32_bf16 v18, v81, v7
  v_dot2c_f32_bf16 v19, v85, v7
  v_dot2c_f32_bf16 v16, v74, v8
  v_dot2c_f32_bf16 v17, v78, v8
  v_dot2c_f32_bf16 v18, v82, v8
  v_dot2c_f32_bf16 v19, v86, v8
  v_dot2c_f32_bf16 v16, v75, v9
  v_dot2c_f32_bf16 v17, v79, v9
  v_dot2c_f32_bf16 v18, v83, v9
  v_dot2c_f32_bf16 v19, v87, v9
  s_nop 2
  v_add_f32_dpp v16, v16, v16 row_ror:8 row_mask:0xf bank_mask:0x3
  v_add_f32_dpp v16, v18, v18 row_ror:8 row_mask:0xf bank_mask:0xc
  v_add_f32_dpp v17, v17, v17 row_ror:8 row_mask:0xf bank_mask:0x3
  v_add_f32_dpp v17, v19, v19 row_ror:8 row_mask:0xf bank_mask:0xc
  s_nop 0
  v_add_f32_dpp v16, v16, v16 row_shl:4 row_mask:0xf bank_mask:0x5
  s_nop 0
  v_add_f32_dpp v16, v17, v17 row_shr:4 row_mask:0xf bank_mask:0xa
  s_nop 1
  v_add_f32_dpp v16, v16, v16 quad_perm:[1,0,3,2] row_mask:0xf bank_mask:0xf
  s_nop 1
  v_add_f32_dpp v16, v16, v16 quad_perm:[2,3,0,1] row_mask:0xf bank_mask:0xf
  v_cvt_pk_bf16_f32 v16, v16, v16
  v_and_b32 v16, 0xffff0000, v16
  v_mul_f32 v16, 0x3db504f3, v16
  v_cvt_pk_bf16_f32 v27, v16, v16
  v_and_b32 v27, 0xffff0000, v27
  v_max_f32 v164, v164, v27
  s_waitcnt vmcnt(2)
  s_add_u32 s58, s57, 786432
  buffer_load_dwordx4 v[112:115], v1, s[28:31], s58 offen offset:3072 nt
  v_dot2_f32_bf16 v16, v88, v6, 0
  v_dot2_f32_bf16 v17, v92, v6, 0
  v_dot2_f32_bf16 v18, v160, v6, 0
  v_dot2_f32_bf16 v19, v156, v6, 0
  v_dot2c_f32_bf16 v16, v89, v7
  v_dot2c_f32_bf16 v17, v93, v7
  v_dot2c_f32_bf16 v18, v161, v7
  v_dot2c_f32_bf16 v19, v157, v7
  v_dot2c_f32_bf16 v16, v90, v8
  v_dot2c_f32_bf16 v17, v94, v8
  v_dot2c_f32_bf16 v18, v162, v8
  v_dot2c_f32_bf16 v19, v158, v8
  v_dot2c_f32_bf16 v16, v91, v9
  v_dot2c_f32_bf16 v17, v95, v9
  v_dot2c_f32_bf16 v18, v163, v9
  v_dot2c_f32_bf16 v19, v159, v9
  s_nop 2
  v_add_f32_dpp v16, v16, v16 row_ror:8 row_mask:0xf bank_mask:0x3
  v_add_f32_dpp v16, v18, v18 row_ror:8 row_mask:0xf bank_mask:0xc
  v_add_f32_dpp v17, v17, v17 row_ror:8 row_mask:0xf bank_mask:0x3
  v_add_f32_dpp v17, v19, v19 row_ror:8 row_mask:0xf bank_mask:0xc
  s_nop 0
  v_add_f32_dpp v16, v16, v16 row_shl:4 row_mask:0xf bank_mask:0x5
  s_nop 0
  v_add_f32_dpp v16, v17, v17 row_shr:4 row_mask:0xf bank_mask:0xa
  s_nop 1
  v_add_f32_dpp v16, v16, v16 quad_perm:[1,0,3,2] row_mask:0xf bank_mask:0xf
  s_nop 1
  v_add_f32_dpp v16, v16, v16 quad_perm:[2,3,0,1] row_mask:0xf bank_mask:0xf
  v_cvt_pk_bf16_f32 v16, v16, v16
  v_and_b32 v16, 0xffff0000, v16
  v_mul_f32 v16, 0x3db504f3, v16
  v_cvt_pk_bf16_f32 v28, v16, v16
  v_and_b32 v28, 0xffff0000, v28
  v_max_f32 v164, v164, v28
  v_dot2_f32_bf16 v16, v152, v6, 0
  v_dot2_f32_bf16 v17, v136, v6, 0
  v_dot2_f32_bf16 v18, v132, v6, 0
  v_dot2_f32_bf16 v19, v128, v6, 0
  v_dot2c_f32_bf16 v16, v153, v7
  v_dot2c_f32_bf16 v17, v137, v7
  v_dot2c_f32_bf16 v18, v133, v7
  v_dot2c_f32_bf16 v19, v129, v7
  v_dot2c_f32_bf16 v16, v154, v8
  v_dot2c_f32_bf16 v17, v138, v8
  v_dot2c_f32_bf16 v18, v134, v8
  v_dot2c_f32_bf16 v19, v130, v8
  v_dot2c_f32_bf16 v16, v155, v9
  v_dot2c_f32_bf16 v17, v139, v9
  v_dot2c_f32_bf16 v18, v135, v9
  v_dot2c_f32_bf16 v19, v131, v9
  s_nop 2
  v_add_f32_dpp v16, v16, v16 row_ror:8 row_mask:0xf bank_mask:0x3
  v_add_f32_dpp v16, v18, v18 row_ror:8 row_mask:0xf bank_mask:0xc
  v_add_f32_dpp v17, v17, v17 row_ror:8 row_mask:0xf bank_mask:0x3
  v_add_f32_dpp v17, v19, v19 row_ror:8 row_mask:0xf bank_mask:0xc
  s_nop 0
  v_add_f32_dpp v16, v16, v16 row_shl:4 row_mask:0xf bank_mask:0x5
  s_nop 0
  v_add_f32_dpp v16, v17, v17 row_shr:4 row_mask:0xf bank_mask:0xa
  s_nop 1
  v_add_f32_dpp v16, v16, v16 quad_perm:[1,0,3,2] row_mask:0xf bank_mask:0xf
  s_nop 1
  v_add_f32_dpp v16, v16, v16 quad_perm:[2,3,0,1] row_mask:0xf bank_mask:0xf
  v_cvt_pk_bf16_f32 v16, v16, v16
  v_and_b32 v16, 0xffff0000, v16
  v_mul_f32 v16, 0x3db504f3, v16
  v_cvt_pk_bf16_f32 v29, v16, v16
  v_and_b32 v29, 0xffff0000, v29
  v_max_f32 v164, v164, v29
  s_waitcnt vmcnt(2)
  s_add_u32 s58, s57, 917504
  buffer_load_dwordx4 v[108:111], v1, s[28:31], s58 offen offset:0 nt
  s_waitcnt vmcnt(2)
  s_add_u32 s58, s57, 917504
  buffer_load_dwordx4 v[104:107], v1, s[28:31], s58 offen offset:1024 nt
  s_movk_i32 s58, 0
  buffer_load_dwordx4 v[100:103], v167, s[48:51], s58 offen offset:0
  s_waitcnt vmcnt(3)
  s_add_u32 s58, s57, 917504
  buffer_load_dwordx4 v[96:99], v1, s[28:31], s58 offen offset:2048 nt
  v_dot2_f32_bf16 v16, v124, v6, 0
  v_dot2_f32_bf16 v17, v120, v6, 0
  v_dot2_f32_bf16 v18, v116, v6, 0
  v_dot2_f32_bf16 v19, v112, v6, 0
  v_dot2c_f32_bf16 v16, v125, v7
  v_dot2c_f32_bf16 v17, v121, v7
  v_dot2c_f32_bf16 v18, v117, v7
  v_dot2c_f32_bf16 v19, v113, v7
  v_dot2c_f32_bf16 v16, v126, v8
  v_dot2c_f32_bf16 v17, v122, v8
  v_dot2c_f32_bf16 v18, v118, v8
  v_dot2c_f32_bf16 v19, v114, v8
  v_dot2c_f32_bf16 v16, v127, v9
  v_dot2c_f32_bf16 v17, v123, v9
  v_dot2c_f32_bf16 v18, v119, v9
  v_dot2c_f32_bf16 v19, v115, v9
  s_nop 2
  v_add_f32_dpp v16, v16, v16 row_ror:8 row_mask:0xf bank_mask:0x3
  v_add_f32_dpp v16, v18, v18 row_ror:8 row_mask:0xf bank_mask:0xc
  v_add_f32_dpp v17, v17, v17 row_ror:8 row_mask:0xf bank_mask:0x3
  v_add_f32_dpp v17, v19, v19 row_ror:8 row_mask:0xf bank_mask:0xc
  s_nop 0
  v_add_f32_dpp v16, v16, v16 row_shl:4 row_mask:0xf bank_mask:0x5
  s_nop 0
  v_add_f32_dpp v16, v17, v17 row_shr:4 row_mask:0xf bank_mask:0xa
  s_nop 1
  v_add_f32_dpp v16, v16, v16 quad_perm:[1,0,3,2] row_mask:0xf bank_mask:0xf
  s_nop 1
  v_add_f32_dpp v16, v16, v16 quad_perm:[2,3,0,1] row_mask:0xf bank_mask:0xf
  v_cvt_pk_bf16_f32 v16, v16, v16
  v_and_b32 v16, 0xffff0000, v16
  v_mul_f32 v16, 0x3db504f3, v16
  v_cvt_pk_bf16_f32 v30, v16, v16
  v_and_b32 v30, 0xffff0000, v30
  v_max_f32 v164, v164, v30
  s_waitcnt vmcnt(3)
  s_add_u32 s58, s57, 917504
  buffer_load_dwordx4 v[148:151], v1, s[28:31], s58 offen offset:3072 nt
  s_movk_i32 s58, 0
  buffer_load_dwordx4 v[144:147], v167, s[48:51], s58 offen offset:256
  s_waitcnt vmcnt(4)
  s_add_u32 s58, s57, 1048576
  buffer_load_dwordx4 v[140:143], v1, s[28:31], s58 offen offset:0 nt
  s_waitcnt vmcnt(3)
  s_add_u32 s58, s57, 1048576
  buffer_load_dwordx4 v[40:43], v1, s[28:31], s58 offen offset:1024 nt
  s_movk_i32 s58, 0
  buffer_load_dwordx4 v[44:47], v167, s[48:51], s58 offen offset:512
  s_waitcnt vmcnt(4)
  s_add_u32 s58, s57, 1048576
  buffer_load_dwordx4 v[48:51], v1, s[28:31], s58 offen offset:2048 nt
  v_dot2_f32_bf16 v16, v108, v6, 0
  v_dot2_f32_bf16 v17, v104, v6, 0
  v_dot2_f32_bf16 v18, v96, v6, 0
  v_dot2_f32_bf16 v19, v148, v6, 0
  v_dot2c_f32_bf16 v16, v109, v7
  v_dot2c_f32_bf16 v17, v105, v7
  v_dot2c_f32_bf16 v18, v97, v7
  v_dot2c_f32_bf16 v19, v149, v7
  v_dot2c_f32_bf16 v16, v110, v8
  v_dot2c_f32_bf16 v17, v106, v8
  v_dot2c_f32_bf16 v18, v98, v8
  v_dot2c_f32_bf16 v19, v150, v8
  v_dot2c_f32_bf16 v16, v111, v9
  v_dot2c_f32_bf16 v17, v107, v9
  v_dot2c_f32_bf16 v18, v99, v9
  v_dot2c_f32_bf16 v19, v151, v9
  s_nop 2
  v_add_f32_dpp v16, v16, v16 row_ror:8 row_mask:0xf bank_mask:0x3
  v_add_f32_dpp v16, v18, v18 row_ror:8 row_mask:0xf bank_mask:0xc
  v_add_f32_dpp v17, v17, v17 row_ror:8 row_mask:0xf bank_mask:0x3
  v_add_f32_dpp v17, v19, v19 row_ror:8 row_mask:0xf bank_mask:0xc
  s_nop 0
  v_add_f32_dpp v16, v16, v16 row_shl:4 row_mask:0xf bank_mask:0x5
  s_nop 0
  v_add_f32_dpp v16, v17, v17 row_shr:4 row_mask:0xf bank_mask:0xa
  s_nop 1
  v_add_f32_dpp v16, v16, v16 quad_perm:[1,0,3,2] row_mask:0xf bank_mask:0xf
  s_nop 1
  v_add_f32_dpp v16, v16, v16 quad_perm:[2,3,0,1] row_mask:0xf bank_mask:0xf
  v_cvt_pk_bf16_f32 v16, v16, v16
  v_and_b32 v16, 0xffff0000, v16
  v_mul_f32 v16, 0x3db504f3, v16
  v_cvt_pk_bf16_f32 v31, v16, v16
  v_and_b32 v31, 0xffff0000, v31
  v_max_f32 v164, v164, v31
  s_waitcnt vmcnt(3)
  s_add_u32 s58, s57, 1048576
  buffer_load_dwordx4 v[52:55], v1, s[28:31], s58 offen offset:3072 nt
  s_movk_i32 s58, 0
  buffer_load_dwordx4 v[56:59], v167, s[48:51], s58 offen offset:768
  s_waitcnt vmcnt(4)
  s_add_u32 s58, s57, 1179648
  buffer_load_dwordx4 v[60:63], v1, s[28:31], s58 offen offset:0 nt
  s_waitcnt vmcnt(3)
  s_add_u32 s58, s57, 1179648
  buffer_load_dwordx4 v[64:67], v1, s[28:31], s58 offen offset:1024 nt
  s_movk_i32 s58, 0
  buffer_load_dwordx4 v[68:71], v167, s[48:51], s58 offen offset:1024
  s_waitcnt vmcnt(4)
  s_add_u32 s58, s57, 1179648
  buffer_load_dwordx4 v[72:75], v1, s[28:31], s58 offen offset:2048 nt
  v_dot2_f32_bf16 v16, v140, v6, 0
  v_dot2_f32_bf16 v17, v40, v6, 0
  v_dot2_f32_bf16 v18, v48, v6, 0
  v_dot2_f32_bf16 v19, v52, v6, 0
  v_dot2c_f32_bf16 v16, v141, v7
  v_dot2c_f32_bf16 v17, v41, v7
  v_dot2c_f32_bf16 v18, v49, v7
  v_dot2c_f32_bf16 v19, v53, v7
  v_dot2c_f32_bf16 v16, v142, v8
  v_dot2c_f32_bf16 v17, v42, v8
  v_dot2c_f32_bf16 v18, v50, v8
  v_dot2c_f32_bf16 v19, v54, v8
  v_dot2c_f32_bf16 v16, v143, v9
  v_dot2c_f32_bf16 v17, v43, v9
  v_dot2c_f32_bf16 v18, v51, v9
  v_dot2c_f32_bf16 v19, v55, v9
  s_nop 2
  v_add_f32_dpp v16, v16, v16 row_ror:8 row_mask:0xf bank_mask:0x3
  v_add_f32_dpp v16, v18, v18 row_ror:8 row_mask:0xf bank_mask:0xc
  v_add_f32_dpp v17, v17, v17 row_ror:8 row_mask:0xf bank_mask:0x3
  v_add_f32_dpp v17, v19, v19 row_ror:8 row_mask:0xf bank_mask:0xc
  s_nop 0
  v_add_f32_dpp v16, v16, v16 row_shl:4 row_mask:0xf bank_mask:0x5
  s_nop 0
  v_add_f32_dpp v16, v17, v17 row_shr:4 row_mask:0xf bank_mask:0xa
  s_nop 1
  v_add_f32_dpp v16, v16, v16 quad_perm:[1,0,3,2] row_mask:0xf bank_mask:0xf
  s_nop 1
  v_add_f32_dpp v16, v16, v16 quad_perm:[2,3,0,1] row_mask:0xf bank_mask:0xf
  v_cvt_pk_bf16_f32 v16, v16, v16
  v_and_b32 v16, 0xffff0000, v16
  v_mul_f32 v16, 0x3db504f3, v16
  v_cvt_pk_bf16_f32 v32, v16, v16
  v_and_b32 v32, 0xffff0000, v32
  v_max_f32 v164, v164, v32
  s_waitcnt vmcnt(3)
  s_add_u32 s58, s57, 1179648
  buffer_load_dwordx4 v[76:79], v1, s[28:31], s58 offen offset:3072 nt
  s_movk_i32 s58, 4608
  buffer_load_dwordx4 v[80:83], v167, s[48:51], s58 offen offset:0
  s_waitcnt vmcnt(4)
  s_add_u32 s58, s57, 1310720
  buffer_load_dwordx4 v[84:87], v1, s[28:31], s58 offen offset:0 nt
  s_waitcnt vmcnt(3)
  s_add_u32 s58, s57, 1310720
  buffer_load_dwordx4 v[88:91], v1, s[28:31], s58 offen offset:1024 nt
  s_movk_i32 s58, 4608
  buffer_load_dwordx4 v[92:95], v167, s[48:51], s58 offen offset:256
  s_waitcnt vmcnt(4)
  s_add_u32 s58, s57, 1310720
  buffer_load_dwordx4 v[160:163], v1, s[28:31], s58 offen offset:2048 nt
  v_dot2_f32_bf16 v16, v60, v6, 0
  v_dot2_f32_bf16 v17, v64, v6, 0
  v_dot2_f32_bf16 v18, v72, v6, 0
  v_dot2_f32_bf16 v19, v76, v6, 0
  v_dot2c_f32_bf16 v16, v61, v7
  v_dot2c_f32_bf16 v17, v65, v7
  v_dot2c_f32_bf16 v18, v73, v7
  v_dot2c_f32_bf16 v19, v77, v7
  v_dot2c_f32_bf16 v16, v62, v8
  v_dot2c_f32_bf16 v17, v66, v8
  v_dot2c_f32_bf16 v18, v74, v8
  v_dot2c_f32_bf16 v19, v78, v8
  v_dot2c_f32_bf16 v16, v63, v9
  v_dot2c_f32_bf16 v17, v67, v9
  v_dot2c_f32_bf16 v18, v75, v9
  v_dot2c_f32_bf16 v19, v79, v9
  s_nop 2
  v_add_f32_dpp v16, v16, v16 row_ror:8 row_mask:0xf bank_mask:0x3
  v_add_f32_dpp v16, v18, v18 row_ror:8 row_mask:0xf bank_mask:0xc
  v_add_f32_dpp v17, v17, v17 row_ror:8 row_mask:0xf bank_mask:0x3
  v_add_f32_dpp v17, v19, v19 row_ror:8 row_mask:0xf bank_mask:0xc
  s_nop 0
  v_add_f32_dpp v16, v16, v16 row_shl:4 row_mask:0xf bank_mask:0x5
  s_nop 0
  v_add_f32_dpp v16, v17, v17 row_shr:4 row_mask:0xf bank_mask:0xa
  s_nop 1
  v_add_f32_dpp v16, v16, v16 quad_perm:[1,0,3,2] row_mask:0xf bank_mask:0xf
  s_nop 1
  v_add_f32_dpp v16, v16, v16 quad_perm:[2,3,0,1] row_mask:0xf bank_mask:0xf
  v_cvt_pk_bf16_f32 v16, v16, v16
  v_and_b32 v16, 0xffff0000, v16
  v_mul_f32 v16, 0x3db504f3, v16
  v_cvt_pk_bf16_f32 v33, v16, v16
  v_and_b32 v33, 0xffff0000, v33
  v_max_f32 v164, v164, v33
  s_waitcnt vmcnt(3)
  s_add_u32 s58, s57, 1310720
  buffer_load_dwordx4 v[156:159], v1, s[28:31], s58 offen offset:3072 nt
  s_movk_i32 s58, 4608
  buffer_load_dwordx4 v[152:155], v167, s[48:51], s58 offen offset:512
  s_waitcnt vmcnt(4)
  s_add_u32 s58, s57, 1441792
  buffer_load_dwordx4 v[136:139], v1, s[28:31], s58 offen offset:0 nt
  s_waitcnt vmcnt(3)
  s_add_u32 s58, s57, 1441792
  buffer_load_dwordx4 v[132:135], v1, s[28:31], s58 offen offset:1024 nt
  s_movk_i32 s58, 4608
  buffer_load_dwordx4 v[128:131], v167, s[48:51], s58 offen offset:768
  s_waitcnt vmcnt(4)
  s_add_u32 s58, s57, 1441792
  buffer_load_dwordx4 v[124:127], v1, s[28:31], s58 offen offset:2048 nt
  v_dot2_f32_bf16 v16, v84, v6, 0
  v_dot2_f32_bf16 v17, v88, v6, 0
  v_dot2_f32_bf16 v18, v160, v6, 0
  v_dot2_f32_bf16 v19, v156, v6, 0
  v_dot2c_f32_bf16 v16, v85, v7
  v_dot2c_f32_bf16 v17, v89, v7
  v_dot2c_f32_bf16 v18, v161, v7
  v_dot2c_f32_bf16 v19, v157, v7
  v_dot2c_f32_bf16 v16, v86, v8
  v_dot2c_f32_bf16 v17, v90, v8
  v_dot2c_f32_bf16 v18, v162, v8
  v_dot2c_f32_bf16 v19, v158, v8
  v_dot2c_f32_bf16 v16, v87, v9
  v_dot2c_f32_bf16 v17, v91, v9
  v_dot2c_f32_bf16 v18, v163, v9
  v_dot2c_f32_bf16 v19, v159, v9
  s_nop 2
  v_add_f32_dpp v16, v16, v16 row_ror:8 row_mask:0xf bank_mask:0x3
  v_add_f32_dpp v16, v18, v18 row_ror:8 row_mask:0xf bank_mask:0xc
  v_add_f32_dpp v17, v17, v17 row_ror:8 row_mask:0xf bank_mask:0x3
  v_add_f32_dpp v17, v19, v19 row_ror:8 row_mask:0xf bank_mask:0xc
  s_nop 0
  v_add_f32_dpp v16, v16, v16 row_shl:4 row_mask:0xf bank_mask:0x5
  s_nop 0
  v_add_f32_dpp v16, v17, v17 row_shr:4 row_mask:0xf bank_mask:0xa
  s_nop 1
  v_add_f32_dpp v16, v16, v16 quad_perm:[1,0,3,2] row_mask:0xf bank_mask:0xf
  s_nop 1
  v_add_f32_dpp v16, v16, v16 quad_perm:[2,3,0,1] row_mask:0xf bank_mask:0xf
  v_cvt_pk_bf16_f32 v16, v16, v16
  v_and_b32 v16, 0xffff0000, v16
  v_mul_f32 v16, 0x3db504f3, v16
  v_cvt_pk_bf16_f32 v34, v16, v16
  v_and_b32 v34, 0xffff0000, v34
  v_max_f32 v164, v164, v34
  s_waitcnt vmcnt(3)
  s_add_u32 s58, s57, 1441792
  buffer_load_dwordx4 v[120:123], v1, s[28:31], s58 offen offset:3072 nt
  s_movk_i32 s58, 4608
  buffer_load_dwordx4 v[116:119], v167, s[48:51], s58 offen offset:1024
  s_waitcnt vmcnt(4)
  s_add_u32 s58, s57, 1572864
  buffer_load_dwordx4 v[112:115], v1, s[28:31], s58 offen offset:0 nt
  s_waitcnt vmcnt(3)
  s_add_u32 s58, s57, 1572864
  buffer_load_dwordx4 v[108:111], v1, s[28:31], s58 offen offset:1024 nt
  s_movk_i32 s58, 9216
  buffer_load_dwordx4 v[104:107], v167, s[48:51], s58 offen offset:0
  s_waitcnt vmcnt(4)
  s_add_u32 s58, s57, 1572864
  buffer_load_dwordx4 v[96:99], v1, s[28:31], s58 offen offset:2048 nt
  v_dot2_f32_bf16 v16, v136, v6, 0
  v_dot2_f32_bf16 v17, v132, v6, 0
  v_dot2_f32_bf16 v18, v124, v6, 0
  v_dot2_f32_bf16 v19, v120, v6, 0
  v_dot2c_f32_bf16 v16, v137, v7
  v_dot2c_f32_bf16 v17, v133, v7
  v_dot2c_f32_bf16 v18, v125, v7
  v_dot2c_f32_bf16 v19, v121, v7
  v_dot2c_f32_bf16 v16, v138, v8
  v_dot2c_f32_bf16 v17, v134, v8
  v_dot2c_f32_bf16 v18, v126, v8
  v_dot2c_f32_bf16 v19, v122, v8
  v_dot2c_f32_bf16 v16, v139, v9
  v_dot2c_f32_bf16 v17, v135, v9
  v_dot2c_f32_bf16 v18, v127, v9
  v_dot2c_f32_bf16 v19, v123, v9
  s_nop 2
  v_add_f32_dpp v16, v16, v16 row_ror:8 row_mask:0xf bank_mask:0x3
  v_add_f32_dpp v16, v18, v18 row_ror:8 row_mask:0xf bank_mask:0xc
  v_add_f32_dpp v17, v17, v17 row_ror:8 row_mask:0xf bank_mask:0x3
  v_add_f32_dpp v17, v19, v19 row_ror:8 row_mask:0xf bank_mask:0xc
  s_nop 0
  v_add_f32_dpp v16, v16, v16 row_shl:4 row_mask:0xf bank_mask:0x5
  s_nop 0
  v_add_f32_dpp v16, v17, v17 row_shr:4 row_mask:0xf bank_mask:0xa
  s_nop 1
  v_add_f32_dpp v16, v16, v16 quad_perm:[1,0,3,2] row_mask:0xf bank_mask:0xf
  s_nop 1
  v_add_f32_dpp v16, v16, v16 quad_perm:[2,3,0,1] row_mask:0xf bank_mask:0xf
  v_cvt_pk_bf16_f32 v16, v16, v16
  v_and_b32 v16, 0xffff0000, v16
  v_mul_f32 v16, 0x3db504f3, v16
  v_cvt_pk_bf16_f32 v35, v16, v16
  v_and_b32 v35, 0xffff0000, v35
  v_max_f32 v164, v164, v35
  s_waitcnt vmcnt(3)
  s_add_u32 s58, s57, 1572864
  buffer_load_dwordx4 v[148:151], v1, s[28:31], s58 offen offset:3072 nt
  s_movk_i32 s58, 9216
  buffer_load_dwordx4 v[140:143], v167, s[48:51], s58 offen offset:256
  s_waitcnt vmcnt(4)
  s_add_u32 s58, s57, 1703936
  buffer_load_dwordx4 v[40:43], v1, s[28:31], s58 offen offset:0 nt
  s_waitcnt vmcnt(3)
  s_add_u32 s58, s57, 1703936
  buffer_load_dwordx4 v[48:51], v1, s[28:31], s58 offen offset:1024 nt
  s_movk_i32 s58, 9216
  buffer_load_dwordx4 v[52:55], v167, s[48:51], s58 offen offset:512
  s_waitcnt vmcnt(4)
  s_add_u32 s58, s57, 1703936
  buffer_load_dwordx4 v[60:63], v1, s[28:31], s58 offen offset:2048 nt
  v_dot2_f32_bf16 v16, v112, v6, 0
  v_dot2_f32_bf16 v17, v108, v6, 0
  v_dot2_f32_bf16 v18, v96, v6, 0
  v_dot2_f32_bf16 v19, v148, v6, 0
  v_dot2c_f32_bf16 v16, v113, v7
  v_dot2c_f32_bf16 v17, v109, v7
  v_dot2c_f32_bf16 v18, v97, v7
  v_dot2c_f32_bf16 v19, v149, v7
  v_dot2c_f32_bf16 v16, v114, v8
  v_dot2c_f32_bf16 v17, v110, v8
  v_dot2c_f32_bf16 v18, v98, v8
  v_dot2c_f32_bf16 v19, v150, v8
  v_dot2c_f32_bf16 v16, v115, v9
  v_dot2c_f32_bf16 v17, v111, v9
  v_dot2c_f32_bf16 v18, v99, v9
  v_dot2c_f32_bf16 v19, v151, v9
  s_nop 2
  v_add_f32_dpp v16, v16, v16 row_ror:8 row_mask:0xf bank_mask:0x3
  v_add_f32_dpp v16, v18, v18 row_ror:8 row_mask:0xf bank_mask:0xc
  v_add_f32_dpp v17, v17, v17 row_ror:8 row_mask:0xf bank_mask:0x3
  v_add_f32_dpp v17, v19, v19 row_ror:8 row_mask:0xf bank_mask:0xc
  s_nop 0
  v_add_f32_dpp v16, v16, v16 row_shl:4 row_mask:0xf bank_mask:0x5
  s_nop 0
  v_add_f32_dpp v16, v17, v17 row_shr:4 row_mask:0xf bank_mask:0xa
  s_nop 1
  v_add_f32_dpp v16, v16, v16 quad_perm:[1,0,3,2] row_mask:0xf bank_mask:0xf
  s_nop 1
  v_add_f32_dpp v16, v16, v16 quad_perm:[2,3,0,1] row_mask:0xf bank_mask:0xf
  v_cvt_pk_bf16_f32 v16, v16, v16
  v_and_b32 v16, 0xffff0000, v16
  v_mul_f32 v16, 0x3db504f3, v16
  v_cvt_pk_bf16_f32 v36, v16, v16
  v_and_b32 v36, 0xffff0000, v36
  v_max_f32 v164, v164, v36
  s_waitcnt vmcnt(3)
  s_add_u32 s58, s57, 1703936
  buffer_load_dwordx4 v[64:67], v1, s[28:31], s58 offen offset:3072 nt
  s_movk_i32 s58, 9216
  buffer_load_dwordx4 v[72:75], v167, s[48:51], s58 offen offset:768
  s_waitcnt vmcnt(4)
  s_add_u32 s58, s57, 1835008
  buffer_load_dwordx4 v[76:79], v1, s[28:31], s58 offen offset:0 nt
  s_waitcnt vmcnt(3)
  s_add_u32 s58, s57, 1835008
  buffer_load_dwordx4 v[84:87], v1, s[28:31], s58 offen offset:1024 nt
  s_movk_i32 s58, 9216
  buffer_load_dwordx4 v[88:91], v167, s[48:51], s58 offen offset:1024
  s_waitcnt vmcnt(4)
  s_add_u32 s58, s57, 1835008
  buffer_load_dwordx4 v[160:163], v1, s[28:31], s58 offen offset:2048 nt
  v_dot2_f32_bf16 v16, v40, v6, 0
  v_dot2_f32_bf16 v17, v48, v6, 0
  v_dot2_f32_bf16 v18, v60, v6, 0
  v_dot2_f32_bf16 v19, v64, v6, 0
  v_dot2c_f32_bf16 v16, v41, v7
  v_dot2c_f32_bf16 v17, v49, v7
  v_dot2c_f32_bf16 v18, v61, v7
  v_dot2c_f32_bf16 v19, v65, v7
  v_dot2c_f32_bf16 v16, v42, v8
  v_dot2c_f32_bf16 v17, v50, v8
  v_dot2c_f32_bf16 v18, v62, v8
  v_dot2c_f32_bf16 v19, v66, v8
  v_dot2c_f32_bf16 v16, v43, v9
  v_dot2c_f32_bf16 v17, v51, v9
  v_dot2c_f32_bf16 v18, v63, v9
  v_dot2c_f32_bf16 v19, v67, v9
  s_nop 2
  v_add_f32_dpp v16, v16, v16 row_ror:8 row_mask:0xf bank_mask:0x3
  v_add_f32_dpp v16, v18, v18 row_ror:8 row_mask:0xf bank_mask:0xc
  v_add_f32_dpp v17, v17, v17 row_ror:8 row_mask:0xf bank_mask:0x3
  v_add_f32_dpp v17, v19, v19 row_ror:8 row_mask:0xf bank_mask:0xc
  s_nop 0
  v_add_f32_dpp v16, v16, v16 row_shl:4 row_mask:0xf bank_mask:0x5
  s_nop 0
  v_add_f32_dpp v16, v17, v17 row_shr:4 row_mask:0xf bank_mask:0xa
  s_nop 1
  v_add_f32_dpp v16, v16, v16 quad_perm:[1,0,3,2] row_mask:0xf bank_mask:0xf
  s_nop 1
  v_add_f32_dpp v16, v16, v16 quad_perm:[2,3,0,1] row_mask:0xf bank_mask:0xf
  v_cvt_pk_bf16_f32 v16, v16, v16
  v_and_b32 v16, 0xffff0000, v16
  v_mul_f32 v16, 0x3db504f3, v16
  v_cvt_pk_bf16_f32 v37, v16, v16
  v_and_b32 v37, 0xffff0000, v37
  v_max_f32 v164, v164, v37
  s_waitcnt vmcnt(3)
  s_add_u32 s58, s57, 1835008
  buffer_load_dwordx4 v[156:159], v1, s[28:31], s58 offen offset:3072 nt
  s_movk_i32 s58, 13824
  buffer_load_dwordx4 v[136:139], v167, s[48:51], s58 offen offset:0
  s_waitcnt vmcnt(4)
  s_add_u32 s58, s57, 1966080
  buffer_load_dwordx4 v[132:135], v1, s[28:31], s58 offen offset:0 nt
  s_waitcnt vmcnt(3)
  s_add_u32 s58, s57, 1966080
  buffer_load_dwordx4 v[124:127], v1, s[28:31], s58 offen offset:1024 nt
  s_movk_i32 s58, 13824
  buffer_load_dwordx4 v[120:123], v167, s[48:51], s58 offen offset:256
  s_waitcnt vmcnt(4)
  s_add_u32 s58, s57, 1966080
  buffer_load_dwordx4 v[112:115], v1, s[28:31], s58 offen offset:2048 nt
  v_dot2_f32_bf16 v16, v76, v6, 0
  v_dot2_f32_bf16 v17, v84, v6, 0
  v_dot2_f32_bf16 v18, v160, v6, 0
  v_dot2_f32_bf16 v19, v156, v6, 0
  v_dot2c_f32_bf16 v16, v77, v7
  v_dot2c_f32_bf16 v17, v85, v7
  v_dot2c_f32_bf16 v18, v161, v7
  v_dot2c_f32_bf16 v19, v157, v7
  v_dot2c_f32_bf16 v16, v78, v8
  v_dot2c_f32_bf16 v17, v86, v8
  v_dot2c_f32_bf16 v18, v162, v8
  v_dot2c_f32_bf16 v19, v158, v8
  v_dot2c_f32_bf16 v16, v79, v9
  v_dot2c_f32_bf16 v17, v87, v9
  v_dot2c_f32_bf16 v18, v163, v9
  v_dot2c_f32_bf16 v19, v159, v9
  s_nop 2
  v_add_f32_dpp v16, v16, v16 row_ror:8 row_mask:0xf bank_mask:0x3
  v_add_f32_dpp v16, v18, v18 row_ror:8 row_mask:0xf bank_mask:0xc
  v_add_f32_dpp v17, v17, v17 row_ror:8 row_mask:0xf bank_mask:0x3
  v_add_f32_dpp v17, v19, v19 row_ror:8 row_mask:0xf bank_mask:0xc
  s_nop 0
  v_add_f32_dpp v16, v16, v16 row_shl:4 row_mask:0xf bank_mask:0x5
  s_nop 0
  v_add_f32_dpp v16, v17, v17 row_shr:4 row_mask:0xf bank_mask:0xa
  s_nop 1
  v_add_f32_dpp v16, v16, v16 quad_perm:[1,0,3,2] row_mask:0xf bank_mask:0xf
  s_nop 1
  v_add_f32_dpp v16, v16, v16 quad_perm:[2,3,0,1] row_mask:0xf bank_mask:0xf
  v_cvt_pk_bf16_f32 v16, v16, v16
  v_and_b32 v16, 0xffff0000, v16
  v_mul_f32 v16, 0x3db504f3, v16
  v_cvt_pk_bf16_f32 v38, v16, v16
  v_and_b32 v38, 0xffff0000, v38
  v_max_f32 v164, v164, v38
  s_waitcnt vmcnt(3)
  s_add_u32 s58, s57, 1966080
  buffer_load_dwordx4 v[108:111], v1, s[28:31], s58 offen offset:3072 nt
  s_movk_i32 s58, 13824
  buffer_load_dwordx4 v[96:99], v167, s[48:51], s58 offen offset:512
  s_waitcnt vmcnt(4)
  s_add_u32 s58, s57, 0
  buffer_load_dwordx4 v[148:151], v1, s[32:35], s58 offen offset:0 nt
  s_waitcnt vmcnt(3)
  s_add_u32 s58, s57, 0
  buffer_load_dwordx4 v[40:43], v1, s[32:35], s58 offen offset:1024 nt
  s_movk_i32 s58, 13824
  buffer_load_dwordx4 v[48:51], v167, s[48:51], s58 offen offset:768
  s_waitcnt vmcnt(4)
  s_add_u32 s58, s57, 0
  buffer_load_dwordx4 v[60:63], v1, s[32:35], s58 offen offset:2048 nt
  v_dot2_f32_bf16 v16, v132, v6, 0
  v_dot2_f32_bf16 v17, v124, v6, 0
  v_dot2_f32_bf16 v18, v112, v6, 0
  v_dot2_f32_bf16 v19, v108, v6, 0
  v_dot2c_f32_bf16 v16, v133, v7
  v_dot2c_f32_bf16 v17, v125, v7
  v_dot2c_f32_bf16 v18, v113, v7
  v_dot2c_f32_bf16 v19, v109, v7
  v_dot2c_f32_bf16 v16, v134, v8
  v_dot2c_f32_bf16 v17, v126, v8
  v_dot2c_f32_bf16 v18, v114, v8
  v_dot2c_f32_bf16 v19, v110, v8
  v_dot2c_f32_bf16 v16, v135, v9
  v_dot2c_f32_bf16 v17, v127, v9
  v_dot2c_f32_bf16 v18, v115, v9
  v_dot2c_f32_bf16 v19, v111, v9
  s_nop 2
  v_add_f32_dpp v16, v16, v16 row_ror:8 row_mask:0xf bank_mask:0x3
  v_add_f32_dpp v16, v18, v18 row_ror:8 row_mask:0xf bank_mask:0xc
  v_add_f32_dpp v17, v17, v17 row_ror:8 row_mask:0xf bank_mask:0x3
  v_add_f32_dpp v17, v19, v19 row_ror:8 row_mask:0xf bank_mask:0xc
  s_nop 0
  v_add_f32_dpp v16, v16, v16 row_shl:4 row_mask:0xf bank_mask:0x5
  s_nop 0
  v_add_f32_dpp v16, v17, v17 row_shr:4 row_mask:0xf bank_mask:0xa
  s_nop 1
  v_add_f32_dpp v16, v16, v16 quad_perm:[1,0,3,2] row_mask:0xf bank_mask:0xf
  s_nop 1
  v_add_f32_dpp v16, v16, v16 quad_perm:[2,3,0,1] row_mask:0xf bank_mask:0xf
  v_cvt_pk_bf16_f32 v16, v16, v16
  v_and_b32 v16, 0xffff0000, v16
  v_mul_f32 v16, 0x3db504f3, v16
  v_cvt_pk_bf16_f32 v39, v16, v16
  v_and_b32 v39, 0xffff0000, v39
  v_max_f32 v164, v164, v39
  s_movk_i32 s58, 13824
  buffer_load_dwordx4 v[64:67], v167, s[48:51], s58 offen offset:1024
  s_nop 1
  v_max_f32_dpp v164, v164, v164 row_ror:8 row_mask:0xf bank_mask:0xf
  s_nop 1
  v_max_f32_dpp v164, v164, v164 row_ror:4 row_mask:0xf bank_mask:0xf
  v_mov_b32 v10, v164
  s_nop 1
  v_permlane16_swap_b32 v164, v10
  s_nop 1
  v_max_f32 v164, v164, v10
  v_mov_b32 v10, v164
  s_nop 1
  v_permlane32_swap_b32 v164, v10
  s_nop 1
  v_max_f32 v164, v164, v10
  v_mul_f32 v164, 0x3fb8aa3b, v164
  s_mov_b32 s56, 0x3fb8aa3b
  v_mov_b32 v165, 0
  v_fma_f32 v24, v24, s56, -v164
  v_fma_f32 v25, v25, s56, -v164
  v_fma_f32 v26, v26, s56, -v164
  v_fma_f32 v27, v27, s56, -v164
  v_fma_f32 v28, v28, s56, -v164
  v_fma_f32 v29, v29, s56, -v164
  v_fma_f32 v30, v30, s56, -v164
  v_fma_f32 v31, v31, s56, -v164
  v_exp_f32 v24, v24
  v_exp_f32 v25, v25
  v_exp_f32 v26, v26
  v_exp_f32 v27, v27
  v_exp_f32 v28, v28
  v_exp_f32 v29, v29
  v_exp_f32 v30, v30
  v_exp_f32 v31, v31
  s_waitcnt vmcnt(4)
  s_add_u32 s58, s57, 0
  buffer_load_dwordx4 v[76:79], v1, s[32:35], s58 offen offset:3072 nt
  v_fma_f32 v32, v32, s56, -v164
  v_fma_f32 v33, v33, s56, -v164
  v_fma_f32 v34, v34, s56, -v164
  v_fma_f32 v35, v35, s56, -v164
  v_fma_f32 v36, v36, s56, -v164
  v_fma_f32 v37, v37, s56, -v164
  v_fma_f32 v38, v38, s56, -v164
  v_fma_f32 v39, v39, s56, -v164
  v_exp_f32 v32, v32
  v_exp_f32 v33, v33
  v_exp_f32 v34, v34
  v_exp_f32 v35, v35
  v_exp_f32 v36, v36
  v_exp_f32 v37, v37
  v_exp_f32 v38, v38
  v_exp_f32 v39, v39
  s_waitcnt vmcnt(4)
  s_add_u32 s58, s57, 131072
  buffer_load_dwordx4 v[84:87], v1, s[32:35], s58 offen offset:0 nt
  v_add_f32 v165, v165, v24
  v_cvt_pk_bf16_f32 v24, v24, v24
  v_add_f32 v165, v165, v25
  v_cvt_pk_bf16_f32 v25, v25, v25
  v_add_f32 v165, v165, v26
  v_cvt_pk_bf16_f32 v26, v26, v26
  v_add_f32 v165, v165, v27
  v_cvt_pk_bf16_f32 v27, v27, v27
  v_add_f32 v165, v165, v28
  v_cvt_pk_bf16_f32 v28, v28, v28
  v_add_f32 v165, v165, v29
  v_cvt_pk_bf16_f32 v29, v29, v29
  v_add_f32 v165, v165, v30
  v_cvt_pk_bf16_f32 v30, v30, v30
  v_add_f32 v165, v165, v31
  v_cvt_pk_bf16_f32 v31, v31, v31
  v_add_f32 v165, v165, v32
  v_cvt_pk_bf16_f32 v32, v32, v32
  v_add_f32 v165, v165, v33
  v_cvt_pk_bf16_f32 v33, v33, v33
  v_add_f32 v165, v165, v34
  v_cvt_pk_bf16_f32 v34, v34, v34
  v_add_f32 v165, v165, v35
  v_cvt_pk_bf16_f32 v35, v35, v35
  v_add_f32 v165, v165, v36
  v_cvt_pk_bf16_f32 v36, v36, v36
  v_add_f32 v165, v165, v37
  v_cvt_pk_bf16_f32 v37, v37, v37
  v_add_f32 v165, v165, v38
  v_cvt_pk_bf16_f32 v38, v38, v38
  v_add_f32 v165, v165, v39
  v_cvt_pk_bf16_f32 v39, v39, v39
  s_nop 1
  v_add_f32_dpp v165, v165, v165 row_ror:8 row_mask:0xf bank_mask:0xf
  s_nop 1
  v_add_f32_dpp v165, v165, v165 row_ror:4 row_mask:0xf bank_mask:0xf
  v_mov_b32 v10, v165
  s_nop 1
  v_permlane16_swap_b32 v165, v10
  s_nop 1
  v_add_f32 v165, v165, v10
  v_mov_b32 v10, v165
  s_nop 1
  v_permlane32_swap_b32 v165, v10
  s_nop 1
  v_add_f32 v165, v165, v10
  s_lshl_b32 s56, s3, 3
  v_mov_b32 v10, s56
  v_mov_b32 v11, 1
  v_mov_b32 v6, 0
  s_mov_b64 exec, 1
  ds_write_b64 v10, v[164:165] offset:13120
  ds_add_u32 v6, v11 offset:13068
  s_mov_b64 exec, -1
  v_subrev_u32 v167, s84, v167
  v_mov_b32 v12, 0
  v_mov_b32 v13, 0
  v_mov_b32 v14, 0
  v_mov_b32 v15, 0
  v_and_b32_dpp v16, v24, v2 row_newbcast:0 row_mask:0xf bank_mask:0xf
  v_and_b32_dpp v17, v24, v3 row_newbcast:0 row_mask:0xf bank_mask:0xf
  v_and_b32_dpp v18, v24, v4 row_newbcast:0 row_mask:0xf bank_mask:0xf
  v_and_b32_dpp v19, v24, v5 row_newbcast:0 row_mask:0xf bank_mask:0xf
  v_and_b32_dpp v20, v24, v2 row_newbcast:4 row_mask:0xf bank_mask:0xf
  v_and_b32_dpp v21, v24, v3 row_newbcast:4 row_mask:0xf bank_mask:0xf
  v_and_b32_dpp v22, v24, v4 row_newbcast:4 row_mask:0xf bank_mask:0xf
  v_and_b32_dpp v23, v24, v5 row_newbcast:4 row_mask:0xf bank_mask:0xf
  v_mfma_f32_16x16x32_bf16 v[12:15], v[16:19], v[148:151], v[12:15]
  v_and_b32_dpp v16, v24, v2 row_newbcast:8 row_mask:0xf bank_mask:0xf
  v_and_b32_dpp v17, v24, v3 row_newbcast:8 row_mask:0xf bank_mask:0xf
  v_and_b32_dpp v18, v24, v4 row_newbcast:8 row_mask:0xf bank_mask:0xf
  v_and_b32_dpp v19, v24, v5 row_newbcast:8 row_mask:0xf bank_mask:0xf
  v_mfma_f32_16x16x32_bf16 v[12:15], v[20:23], v[40:43], v[12:15]
  s_waitcnt vmcnt(3)
  s_add_u32 s58, s57, 131072
  buffer_load_dwordx4 v[160:163], v1, s[32:35], s58 offen offset:1024 nt
  v_and_b32_dpp v20, v24, v2 row_newbcast:12 row_mask:0xf bank_mask:0xf
  v_and_b32_dpp v21, v24, v3 row_newbcast:12 row_mask:0xf bank_mask:0xf
  v_and_b32_dpp v22, v24, v4 row_newbcast:12 row_mask:0xf bank_mask:0xf
  v_and_b32_dpp v23, v24, v5 row_newbcast:12 row_mask:0xf bank_mask:0xf
  v_mfma_f32_16x16x32_bf16 v[12:15], v[16:19], v[60:63], v[12:15]
  s_waitcnt vmcnt(2)
  s_add_u32 s58, s57, 131072
  buffer_load_dwordx4 v[156:159], v1, s[32:35], s58 offen offset:2048 nt
  v_and_b32_dpp v16, v25, v2 row_newbcast:0 row_mask:0xf bank_mask:0xf
  v_and_b32_dpp v17, v25, v3 row_newbcast:0 row_mask:0xf bank_mask:0xf
  v_and_b32_dpp v18, v25, v4 row_newbcast:0 row_mask:0xf bank_mask:0xf
  v_and_b32_dpp v19, v25, v5 row_newbcast:0 row_mask:0xf bank_mask:0xf
  v_mfma_f32_16x16x32_bf16 v[12:15], v[20:23], v[76:79], v[12:15]
  s_waitcnt vmcnt(2)
  s_add_u32 s58, s57, 131072
  buffer_load_dwordx4 v[132:135], v1, s[32:35], s58 offen offset:3072 nt
  buffer_load_dwordx4 v[124:127], v167, s[36:39], s86 offen offset:0
  v_and_b32_dpp v20, v25, v2 row_newbcast:4 row_mask:0xf bank_mask:0xf
  v_and_b32_dpp v21, v25, v3 row_newbcast:4 row_mask:0xf bank_mask:0xf
  v_and_b32_dpp v22, v25, v4 row_newbcast:4 row_mask:0xf bank_mask:0xf
  v_and_b32_dpp v23, v25, v5 row_newbcast:4 row_mask:0xf bank_mask:0xf
  v_mfma_f32_16x16x32_bf16 v[12:15], v[16:19], v[84:87], v[12:15]
  s_waitcnt vmcnt(3)
  s_add_u32 s58, s57, 262144
  buffer_load_dwordx4 v[112:115], v1, s[32:35], s58 offen offset:0 nt
  v_and_b32_dpp v16, v25, v2 row_newbcast:8 row_mask:0xf bank_mask:0xf
  v_and_b32_dpp v17, v25, v3 row_newbcast:8 row_mask:0xf bank_mask:0xf
  v_and_b32_dpp v18, v25, v4 row_newbcast:8 row_mask:0xf bank_mask:0xf
  v_and_b32_dpp v19, v25, v5 row_newbcast:8 row_mask:0xf bank_mask:0xf
  v_mfma_f32_16x16x32_bf16 v[12:15], v[20:23], v[160:163], v[12:15]
  s_waitcnt vmcnt(3)
  s_add_u32 s58, s57, 262144
  buffer_load_dwordx4 v[108:111], v1, s[32:35], s58 offen offset:1024 nt
  buffer_load_dwordx4 v[148:151], v167, s[36:39], s86 offen offset:256
  v_and_b32_dpp v20, v25, v2 row_newbcast:12 row_mask:0xf bank_mask:0xf
  v_and_b32_dpp v21, v25, v3 row_newbcast:12 row_mask:0xf bank_mask:0xf
  v_and_b32_dpp v22, v25, v4 row_newbcast:12 row_mask:0xf bank_mask:0xf
  v_and_b32_dpp v23, v25, v5 row_newbcast:12 row_mask:0xf bank_mask:0xf
  v_mfma_f32_16x16x32_bf16 v[12:15], v[16:19], v[156:159], v[12:15]
  s_waitcnt vmcnt(4)
  s_add_u32 s58, s57, 262144
  buffer_load_dwordx4 v[40:43], v1, s[32:35], s58 offen offset:2048 nt
  v_and_b32_dpp v16, v26, v2 row_newbcast:0 row_mask:0xf bank_mask:0xf
  v_and_b32_dpp v17, v26, v3 row_newbcast:0 row_mask:0xf bank_mask:0xf
  v_and_b32_dpp v18, v26, v4 row_newbcast:0 row_mask:0xf bank_mask:0xf
  v_and_b32_dpp v19, v26, v5 row_newbcast:0 row_mask:0xf bank_mask:0xf
  v_mfma_f32_16x16x32_bf16 v[12:15], v[20:23], v[132:135], v[12:15]
  s_waitcnt vmcnt(3)
  s_add_u32 s58, s57, 262144
  buffer_load_dwordx4 v[60:63], v1, s[32:35], s58 offen offset:3072 nt
  buffer_load_dwordx4 v[76:79], v167, s[36:39], s86 offen offset:512
  v_and_b32_dpp v20, v26, v2 row_newbcast:4 row_mask:0xf bank_mask:0xf
  v_and_b32_dpp v21, v26, v3 row_newbcast:4 row_mask:0xf bank_mask:0xf
  v_and_b32_dpp v22, v26, v4 row_newbcast:4 row_mask:0xf bank_mask:0xf
  v_and_b32_dpp v23, v26, v5 row_newbcast:4 row_mask:0xf bank_mask:0xf
  v_mfma_f32_16x16x32_bf16 v[12:15], v[16:19], v[112:115], v[12:15]
  s_waitcnt vmcnt(4)
  s_add_u32 s58, s57, 393216
  buffer_load_dwordx4 v[84:87], v1, s[32:35], s58 offen offset:0 nt
  v_and_b32_dpp v16, v26, v2 row_newbcast:8 row_mask:0xf bank_mask:0xf
  v_and_b32_dpp v17, v26, v3 row_newbcast:8 row_mask:0xf bank_mask:0xf
  v_and_b32_dpp v18, v26, v4 row_newbcast:8 row_mask:0xf bank_mask:0xf
  v_and_b32_dpp v19, v26, v5 row_newbcast:8 row_mask:0xf bank_mask:0xf
  v_mfma_f32_16x16x32_bf16 v[12:15], v[20:23], v[108:111], v[12:15]
  s_waitcnt vmcnt(3)
  s_add_u32 s58, s57, 393216
  buffer_load_dwordx4 v[160:163], v1, s[32:35], s58 offen offset:1024 nt
  buffer_load_dwordx4 v[156:159], v167, s[36:39], s86 offen offset:768
  v_and_b32_dpp v20, v26, v2 row_newbcast:12 row_mask:0xf bank_mask:0xf
  v_and_b32_dpp v21, v26, v3 row_newbcast:12 row_mask:0xf bank_mask:0xf
  v_and_b32_dpp v22, v26, v4 row_newbcast:12 row_mask:0xf bank_mask:0xf
  v_and_b32_dpp v23, v26, v5 row_newbcast:12 row_mask:0xf bank_mask:0xf
  v_mfma_f32_16x16x32_bf16 v[12:15], v[16:19], v[40:43], v[12:15]
  s_waitcnt vmcnt(4)
  s_add_u32 s58, s57, 393216
  buffer_load_dwordx4 v[132:135], v1, s[32:35], s58 offen offset:2048 nt
  v_and_b32_dpp v16, v27, v2 row_newbcast:0 row_mask:0xf bank_mask:0xf
  v_and_b32_dpp v17, v27, v3 row_newbcast:0 row_mask:0xf bank_mask:0xf
  v_and_b32_dpp v18, v27, v4 row_newbcast:0 row_mask:0xf bank_mask:0xf
  v_and_b32_dpp v19, v27, v5 row_newbcast:0 row_mask:0xf bank_mask:0xf
  v_mfma_f32_16x16x32_bf16 v[12:15], v[20:23], v[60:63], v[12:15]
  s_waitcnt vmcnt(3)
  s_add_u32 s58, s57, 393216
  buffer_load_dwordx4 v[112:115], v1, s[32:35], s58 offen offset:3072 nt
  buffer_load_dwordx4 v[108:111], v167, s[36:39], s86 offen offset:1024
  v_and_b32_dpp v20, v27, v2 row_newbcast:4 row_mask:0xf bank_mask:0xf
  v_and_b32_dpp v21, v27, v3 row_newbcast:4 row_mask:0xf bank_mask:0xf
  v_and_b32_dpp v22, v27, v4 row_newbcast:4 row_mask:0xf bank_mask:0xf
  v_and_b32_dpp v23, v27, v5 row_newbcast:4 row_mask:0xf bank_mask:0xf
  v_mfma_f32_16x16x32_bf16 v[12:15], v[16:19], v[84:87], v[12:15]
  s_waitcnt vmcnt(4)
  s_add_u32 s58, s57, 524288
  buffer_load_dwordx4 v[40:43], v1, s[32:35], s58 offen offset:0 nt
  v_and_b32_dpp v16, v27, v2 row_newbcast:8 row_mask:0xf bank_mask:0xf
  v_and_b32_dpp v17, v27, v3 row_newbcast:8 row_mask:0xf bank_mask:0xf
  v_and_b32_dpp v18, v27, v4 row_newbcast:8 row_mask:0xf bank_mask:0xf
  v_and_b32_dpp v19, v27, v5 row_newbcast:8 row_mask:0xf bank_mask:0xf
  v_mfma_f32_16x16x32_bf16 v[12:15], v[20:23], v[160:163], v[12:15]
  s_waitcnt vmcnt(3)
  s_add_u32 s58, s57, 524288
  buffer_load_dwordx4 v[60:63], v1, s[32:35], s58 offen offset:1024 nt
  v_and_b32_dpp v20, v27, v2 row_newbcast:12 row_mask:0xf bank_mask:0xf
  v_and_b32_dpp v21, v27, v3 row_newbcast:12 row_mask:0xf bank_mask:0xf
  v_and_b32_dpp v22, v27, v4 row_newbcast:12 row_mask:0xf bank_mask:0xf
  v_and_b32_dpp v23, v27, v5 row_newbcast:12 row_mask:0xf bank_mask:0xf
  v_mfma_f32_16x16x32_bf16 v[12:15], v[16:19], v[132:135], v[12:15]
  s_waitcnt vmcnt(3)
  s_add_u32 s58, s57, 524288
  buffer_load_dwordx4 v[84:87], v1, s[32:35], s58 offen offset:2048 nt
  v_and_b32_dpp v16, v28, v2 row_newbcast:0 row_mask:0xf bank_mask:0xf
  v_and_b32_dpp v17, v28, v3 row_newbcast:0 row_mask:0xf bank_mask:0xf
  v_and_b32_dpp v18, v28, v4 row_newbcast:0 row_mask:0xf bank_mask:0xf
  v_and_b32_dpp v19, v28, v5 row_newbcast:0 row_mask:0xf bank_mask:0xf
  v_mfma_f32_16x16x32_bf16 v[12:15], v[20:23], v[112:115], v[12:15]
  s_waitcnt vmcnt(2)
  s_add_u32 s58, s57, 524288
  buffer_load_dwordx4 v[160:163], v1, s[32:35], s58 offen offset:3072 nt
  v_and_b32_dpp v20, v28, v2 row_newbcast:4 row_mask:0xf bank_mask:0xf
  v_and_b32_dpp v21, v28, v3 row_newbcast:4 row_mask:0xf bank_mask:0xf
  v_and_b32_dpp v22, v28, v4 row_newbcast:4 row_mask:0xf bank_mask:0xf
  v_and_b32_dpp v23, v28, v5 row_newbcast:4 row_mask:0xf bank_mask:0xf
  v_mfma_f32_16x16x32_bf16 v[12:15], v[16:19], v[40:43], v[12:15]
  s_waitcnt vmcnt(2)
  s_add_u32 s58, s57, 655360
  buffer_load_dwordx4 v[132:135], v1, s[32:35], s58 offen offset:0 nt
  v_and_b32_dpp v16, v28, v2 row_newbcast:8 row_mask:0xf bank_mask:0xf
  v_and_b32_dpp v17, v28, v3 row_newbcast:8 row_mask:0xf bank_mask:0xf
  v_and_b32_dpp v18, v28, v4 row_newbcast:8 row_mask:0xf bank_mask:0xf
  v_and_b32_dpp v19, v28, v5 row_newbcast:8 row_mask:0xf bank_mask:0xf
  v_mfma_f32_16x16x32_bf16 v[12:15], v[20:23], v[60:63], v[12:15]
  s_waitcnt vmcnt(2)
  s_add_u32 s58, s57, 655360
  buffer_load_dwordx4 v[112:115], v1, s[32:35], s58 offen offset:1024 nt
  v_and_b32_dpp v20, v28, v2 row_newbcast:12 row_mask:0xf bank_mask:0xf
  v_and_b32_dpp v21, v28, v3 row_newbcast:12 row_mask:0xf bank_mask:0xf
  v_and_b32_dpp v22, v28, v4 row_newbcast:12 row_mask:0xf bank_mask:0xf
  v_and_b32_dpp v23, v28, v5 row_newbcast:12 row_mask:0xf bank_mask:0xf
  v_mfma_f32_16x16x32_bf16 v[12:15], v[16:19], v[84:87], v[12:15]
  s_waitcnt vmcnt(2)
  s_add_u32 s58, s57, 655360
  buffer_load_dwordx4 v[24:27], v1, s[32:35], s58 offen offset:2048 nt
  v_and_b32_dpp v16, v29, v2 row_newbcast:0 row_mask:0xf bank_mask:0xf
  v_and_b32_dpp v17, v29, v3 row_newbcast:0 row_mask:0xf bank_mask:0xf
  v_and_b32_dpp v18, v29, v4 row_newbcast:0 row_mask:0xf bank_mask:0xf
  v_and_b32_dpp v19, v29, v5 row_newbcast:0 row_mask:0xf bank_mask:0xf
  v_mfma_f32_16x16x32_bf16 v[12:15], v[20:23], v[160:163], v[12:15]
  s_waitcnt vmcnt(2)
  s_add_u32 s58, s57, 655360
  buffer_load_dwordx4 v[40:43], v1, s[32:35], s58 offen offset:3072 nt
  s_nop 1
  v_mfma_f32_16x16x32_bf16 v[12:15], v[16:19], v[132:135], v[12:15]
  v_mov_b32 v6, 0
L_hw_3:
  ds_read_b32 v11, v6 offset:13064
  s_waitcnt lgkmcnt(0)
  v_cmp_eq_u32 vcc, 0, v11
  s_cbranch_vccz L_hok_4
  s_add_u32 s59, s59, 1
  s_cmp_gt_u32 s59, 4000000
  s_cbranch_scc1 L_hok_4
  s_sleep 2
  s_branch L_hw_3
L_hok_4:
  s_mov_b32 s59, 0
  v_lshrrev_b32 v11, 4, v0
  v_lshlrev_b32 v11, 2, v11
  s_lshl_b32 s56, s3, 4
  v_add_u32 v11, s56, v11
  ds_read_b32 v11, v11 offset:12800
  v_and_b32 v6, 8, v0
  v_cmp_eq_u32 vcc, 0, v6
  s_waitcnt lgkmcnt(0)
  s_nop 0
  v_cndmask_b32 v11, 0, v11, vcc
  v_and_b32 v20, v11, v2
  v_and_b32 v21, v11, v3
  v_and_b32 v22, v11, v4
  v_and_b32 v23, v11, v5
  s_nop 1
  v_mfma_f32_16x16x32_bf16 v[60:63], v[20:23], v[124:127], 0
  v_mfma_f32_16x16x32_bf16 v[84:87], v[20:23], v[148:151], 0
  v_mfma_f32_16x16x32_bf16 v[160:163], v[20:23], v[76:79], 0
  v_mfma_f32_16x16x32_bf16 v[132:135], v[20:23], v[156:159], 0
  v_mfma_f32_16x16x32_bf16 v[124:127], v[20:23], v[108:111], 0
  v_and_b32_dpp v20, v29, v2 row_newbcast:4 row_mask:0xf bank_mask:0xf
  v_and_b32_dpp v21, v29, v3 row_newbcast:4 row_mask:0xf bank_mask:0xf
  v_and_b32_dpp v22, v29, v4 row_newbcast:4 row_mask:0xf bank_mask:0xf
  v_and_b32_dpp v23, v29, v5 row_newbcast:4 row_mask:0xf bank_mask:0xf
  s_nop 1
  s_waitcnt vmcnt(2)
  s_add_u32 s58, s57, 786432
  buffer_load_dwordx4 v[148:151], v1, s[32:35], s58 offen offset:0 nt
  v_and_b32_dpp v16, v29, v2 row_newbcast:8 row_mask:0xf bank_mask:0xf
  v_and_b32_dpp v17, v29, v3 row_newbcast:8 row_mask:0xf bank_mask:0xf
  v_and_b32_dpp v18, v29, v4 row_newbcast:8 row_mask:0xf bank_mask:0xf
  v_and_b32_dpp v19, v29, v5 row_newbcast:8 row_mask:0xf bank_mask:0xf
  v_mfma_f32_16x16x32_bf16 v[12:15], v[20:23], v[112:115], v[12:15]
  s_waitcnt vmcnt(2)
  s_add_u32 s58, s57, 786432
  buffer_load_dwordx4 v[76:79], v1, s[32:35], s58 offen offset:1024 nt
  v_and_b32_dpp v20, v29, v2 row_newbcast:12 row_mask:0xf bank_mask:0xf
  v_and_b32_dpp v21, v29, v3 row_newbcast:12 row_mask:0xf bank_mask:0xf
  v_and_b32_dpp v22, v29, v4 row_newbcast:12 row_mask:0xf bank_mask:0xf
  v_and_b32_dpp v23, v29, v5 row_newbcast:12 row_mask:0xf bank_mask:0xf
  v_mfma_f32_16x16x32_bf16 v[12:15], v[16:19], v[24:27], v[12:15]
  s_waitcnt vmcnt(2)
  s_add_u32 s58, s57, 786432
  buffer_load_dwordx4 v[156:159], v1, s[32:35], s58 offen offset:2048 nt
  v_and_b32_dpp v16, v30, v2 row_newbcast:0 row_mask:0xf bank_mask:0xf
  v_and_b32_dpp v17, v30, v3 row_newbcast:0 row_mask:0xf bank_mask:0xf
  v_and_b32_dpp v18, v30, v4 row_newbcast:0 row_mask:0xf bank_mask:0xf
  v_and_b32_dpp v19, v30, v5 row_newbcast:0 row_mask:0xf bank_mask:0xf
  v_mfma_f32_16x16x32_bf16 v[12:15], v[20:23], v[40:43], v[12:15]
  s_waitcnt vmcnt(2)
  s_add_u32 s58, s57, 786432
  buffer_load_dwordx4 v[108:111], v1, s[32:35], s58 offen offset:3072 nt
  v_and_b32_dpp v20, v30, v2 row_newbcast:4 row_mask:0xf bank_mask:0xf
  v_and_b32_dpp v21, v30, v3 row_newbcast:4 row_mask:0xf bank_mask:0xf
  v_and_b32_dpp v22, v30, v4 row_newbcast:4 row_mask:0xf bank_mask:0xf
  v_and_b32_dpp v23, v30, v5 row_newbcast:4 row_mask:0xf bank_mask:0xf
  v_mfma_f32_16x16x32_bf16 v[12:15], v[16:19], v[148:151], v[12:15]
  s_waitcnt vmcnt(2)
  s_add_u32 s58, s57, 917504
  buffer_load_dwordx4 v[112:115], v1, s[32:35], s58 offen offset:0 nt
  v_and_b32_dpp v16, v30, v2 row_newbcast:8 row_mask:0xf bank_mask:0xf
  v_and_b32_dpp v17, v30, v3 row_newbcast:8 row_mask:0xf bank_mask:0xf
  v_and_b32_dpp v18, v30, v4 row_newbcast:8 row_mask:0xf bank_mask:0xf
  v_and_b32_dpp v19, v30, v5 row_newbcast:8 row_mask:0xf bank_mask:0xf
  v_mfma_f32_16x16x32_bf16 v[12:15], v[20:23], v[76:79], v[12:15]
  s_waitcnt vmcnt(2)
  s_add_u32 s58, s57, 917504
  buffer_load_dwordx4 v[24:27], v1, s[32:35], s58 offen offset:1024 nt
  v_and_b32_dpp v20, v30, v2 row_newbcast:12 row_mask:0xf bank_mask:0xf
  v_and_b32_dpp v21, v30, v3 row_newbcast:12 row_mask:0xf bank_mask:0xf
  v_and_b32_dpp v22, v30, v4 row_newbcast:12 row_mask:0xf bank_mask:0xf
  v_and_b32_dpp v23, v30, v5 row_newbcast:12 row_mask:0xf bank_mask:0xf
  v_mfma_f32_16x16x32_bf16 v[12:15], v[16:19], v[156:159], v[12:15]
  s_waitcnt vmcnt(2)
  s_add_u32 s58, s57, 917504
  buffer_load_dwordx4 v[40:43], v1, s[32:35], s58 offen offset:2048 nt
  v_and_b32_dpp v16, v31, v2 row_newbcast:0 row_mask:0xf bank_mask:0xf
  v_and_b32_dpp v17, v31, v3 row_newbcast:0 row_mask:0xf bank_mask:0xf
  v_and_b32_dpp v18, v31, v4 row_newbcast:0 row_mask:0xf bank_mask:0xf
  v_and_b32_dpp v19, v31, v5 row_newbcast:0 row_mask:0xf bank_mask:0xf
  v_mfma_f32_16x16x32_bf16 v[12:15], v[20:23], v[108:111], v[12:15]
  s_waitcnt vmcnt(2)
  s_add_u32 s58, s57, 917504
  buffer_load_dwordx4 v[148:151], v1, s[32:35], s58 offen offset:3072 nt
  v_and_b32_dpp v20, v31, v2 row_newbcast:4 row_mask:0xf bank_mask:0xf
  v_and_b32_dpp v21, v31, v3 row_newbcast:4 row_mask:0xf bank_mask:0xf
  v_and_b32_dpp v22, v31, v4 row_newbcast:4 row_mask:0xf bank_mask:0xf
  v_and_b32_dpp v23, v31, v5 row_newbcast:4 row_mask:0xf bank_mask:0xf
  v_mfma_f32_16x16x32_bf16 v[12:15], v[16:19], v[112:115], v[12:15]
  s_waitcnt vmcnt(2)
  s_add_u32 s58, s57, 1048576
  buffer_load_dwordx4 v[76:79], v1, s[32:35], s58 offen offset:0 nt
  v_and_b32_dpp v16, v31, v2 row_newbcast:8 row_mask:0xf bank_mask:0xf
  v_and_b32_dpp v17, v31, v3 row_newbcast:8 row_mask:0xf bank_mask:0xf
  v_and_b32_dpp v18, v31, v4 row_newbcast:8 row_mask:0xf bank_mask:0xf
  v_and_b32_dpp v19, v31, v5 row_newbcast:8 row_mask:0xf bank_mask:0xf
  v_mfma_f32_16x16x32_bf16 v[12:15], v[20:23], v[24:27], v[12:15]
  s_waitcnt vmcnt(2)
  s_add_u32 s58, s57, 1048576
  buffer_load_dwordx4 v[156:159], v1, s[32:35], s58 offen offset:1024 nt
  v_and_b32_dpp v20, v31, v2 row_newbcast:12 row_mask:0xf bank_mask:0xf
  v_and_b32_dpp v21, v31, v3 row_newbcast:12 row_mask:0xf bank_mask:0xf
  v_and_b32_dpp v22, v31, v4 row_newbcast:12 row_mask:0xf bank_mask:0xf
  v_and_b32_dpp v23, v31, v5 row_newbcast:12 row_mask:0xf bank_mask:0xf
  v_mfma_f32_16x16x32_bf16 v[12:15], v[16:19], v[40:43], v[12:15]
  s_waitcnt vmcnt(2)
  s_add_u32 s58, s57, 1048576
  buffer_load_dwordx4 v[108:111], v1, s[32:35], s58 offen offset:2048 nt
  v_and_b32_dpp v16, v32, v2 row_newbcast:0 row_mask:0xf bank_mask:0xf
  v_and_b32_dpp v17, v32, v3 row_newbcast:0 row_mask:0xf bank_mask:0xf
  v_and_b32_dpp v18, v32, v4 row_newbcast:0 row_mask:0xf bank_mask:0xf
  v_and_b32_dpp v19, v32, v5 row_newbcast:0 row_mask:0xf bank_mask:0xf
  v_mfma_f32_16x16x32_bf16 v[12:15], v[20:23], v[148:151], v[12:15]
  s_waitcnt vmcnt(2)
  s_add_u32 s58, s57, 1048576
  buffer_load_dwordx4 v[112:115], v1, s[32:35], s58 offen offset:3072 nt
  v_and_b32_dpp v20, v32, v2 row_newbcast:4 row_mask:0xf bank_mask:0xf
  v_and_b32_dpp v21, v32, v3 row_newbcast:4 row_mask:0xf bank_mask:0xf
  v_and_b32_dpp v22, v32, v4 row_newbcast:4 row_mask:0xf bank_mask:0xf
  v_and_b32_dpp v23, v32, v5 row_newbcast:4 row_mask:0xf bank_mask:0xf
  v_mfma_f32_16x16x32_bf16 v[12:15], v[16:19], v[76:79], v[12:15]
  s_waitcnt vmcnt(2)
  s_add_u32 s58, s57, 1179648
  buffer_load_dwordx4 v[24:27], v1, s[32:35], s58 offen offset:0 nt
  v_and_b32_dpp v16, v32, v2 row_newbcast:8 row_mask:0xf bank_mask:0xf
  v_and_b32_dpp v17, v32, v3 row_newbcast:8 row_mask:0xf bank_mask:0xf
  v_and_b32_dpp v18, v32, v4 row_newbcast:8 row_mask:0xf bank_mask:0xf
  v_and_b32_dpp v19, v32, v5 row_newbcast:8 row_mask:0xf bank_mask:0xf
  v_mfma_f32_16x16x32_bf16 v[12:15], v[20:23], v[156:159], v[12:15]
  s_waitcnt vmcnt(2)
  s_add_u32 s58, s57, 1179648
  buffer_load_dwordx4 v[40:43], v1, s[32:35], s58 offen offset:1024 nt
  v_and_b32_dpp v20, v32, v2 row_newbcast:12 row_mask:0xf bank_mask:0xf
  v_and_b32_dpp v21, v32, v3 row_newbcast:12 row_mask:0xf bank_mask:0xf
  v_and_b32_dpp v22, v32, v4 row_newbcast:12 row_mask:0xf bank_mask:0xf
  v_and_b32_dpp v23, v32, v5 row_newbcast:12 row_mask:0xf bank_mask:0xf
  v_mfma_f32_16x16x32_bf16 v[12:15], v[16:19], v[108:111], v[12:15]
  s_waitcnt vmcnt(2)
  s_add_u32 s58, s57, 1179648
  buffer_load_dwordx4 v[148:151], v1, s[32:35], s58 offen offset:2048 nt
  v_and_b32_dpp v16, v33, v2 row_newbcast:0 row_mask:0xf bank_mask:0xf
  v_and_b32_dpp v17, v33, v3 row_newbcast:0 row_mask:0xf bank_mask:0xf
  v_and_b32_dpp v18, v33, v4 row_newbcast:0 row_mask:0xf bank_mask:0xf
  v_and_b32_dpp v19, v33, v5 row_newbcast:0 row_mask:0xf bank_mask:0xf
  v_mfma_f32_16x16x32_bf16 v[12:15], v[20:23], v[112:115], v[12:15]
  s_waitcnt vmcnt(2)
  s_add_u32 s58, s57, 1179648
  buffer_load_dwordx4 v[28:31], v1, s[32:35], s58 offen offset:3072 nt
  v_and_b32_dpp v20, v33, v2 row_newbcast:4 row_mask:0xf bank_mask:0xf
  v_and_b32_dpp v21, v33, v3 row_newbcast:4 row_mask:0xf bank_mask:0xf
  v_and_b32_dpp v22, v33, v4 row_newbcast:4 row_mask:0xf bank_mask:0xf
  v_and_b32_dpp v23, v33, v5 row_newbcast:4 row_mask:0xf bank_mask:0xf
  v_mfma_f32_16x16x32_bf16 v[12:15], v[16:19], v[24:27], v[12:15]
  s_waitcnt vmcnt(2)
  s_add_u32 s58, s57, 1310720
  buffer_load_dwordx4 v[76:79], v1, s[32:35], s58 offen offset:0 nt
  v_and_b32_dpp v16, v33, v2 row_newbcast:8 row_mask:0xf bank_mask:0xf
  v_and_b32_dpp v17, v33, v3 row_newbcast:8 row_mask:0xf bank_mask:0xf
  v_and_b32_dpp v18, v33, v4 row_newbcast:8 row_mask:0xf bank_mask:0xf
  v_and_b32_dpp v19, v33, v5 row_newbcast:8 row_mask:0xf bank_mask:0xf
  v_mfma_f32_16x16x32_bf16 v[12:15], v[20:23], v[40:43], v[12:15]
  s_waitcnt vmcnt(2)
  s_add_u32 s58, s57, 1310720
  buffer_load_dwordx4 v[156:159], v1, s[32:35], s58 offen offset:1024 nt
  v_and_b32_dpp v20, v33, v2 row_newbcast:12 row_mask:0xf bank_mask:0xf
  v_and_b32_dpp v21, v33, v3 row_newbcast:12 row_mask:0xf bank_mask:0xf
  v_and_b32_dpp v22, v33, v4 row_newbcast:12 row_mask:0xf bank_mask:0xf
  v_and_b32_dpp v23, v33, v5 row_newbcast:12 row_mask:0xf bank_mask:0xf
  v_mfma_f32_16x16x32_bf16 v[12:15], v[16:19], v[148:151], v[12:15]
  s_waitcnt vmcnt(2)
  s_add_u32 s58, s57, 1310720
  buffer_load_dwordx4 v[108:111], v1, s[32:35], s58 offen offset:2048 nt
  v_and_b32_dpp v16, v34, v2 row_newbcast:0 row_mask:0xf bank_mask:0xf
  v_and_b32_dpp v17, v34, v3 row_newbcast:0 row_mask:0xf bank_mask:0xf
  v_and_b32_dpp v18, v34, v4 row_newbcast:0 row_mask:0xf bank_mask:0xf
  v_and_b32_dpp v19, v34, v5 row_newbcast:0 row_mask:0xf bank_mask:0xf
  v_mfma_f32_16x16x32_bf16 v[12:15], v[20:23], v[28:31], v[12:15]
  s_waitcnt vmcnt(2)
  s_add_u32 s58, s57, 1310720
  buffer_load_dwordx4 v[112:115], v1, s[32:35], s58 offen offset:3072 nt
  v_and_b32_dpp v20, v34, v2 row_newbcast:4 row_mask:0xf bank_mask:0xf
  v_and_b32_dpp v21, v34, v3 row_newbcast:4 row_mask:0xf bank_mask:0xf
  v_and_b32_dpp v22, v34, v4 row_newbcast:4 row_mask:0xf bank_mask:0xf
  v_and_b32_dpp v23, v34, v5 row_newbcast:4 row_mask:0xf bank_mask:0xf
  v_mfma_f32_16x16x32_bf16 v[12:15], v[16:19], v[76:79], v[12:15]
  s_waitcnt vmcnt(2)
  s_add_u32 s58, s57, 1441792
  buffer_load_dwordx4 v[24:27], v1, s[32:35], s58 offen offset:0 nt
  v_and_b32_dpp v16, v34, v2 row_newbcast:8 row_mask:0xf bank_mask:0xf
  v_and_b32_dpp v17, v34, v3 row_newbcast:8 row_mask:0xf bank_mask:0xf
  v_and_b32_dpp v18, v34, v4 row_newbcast:8 row_mask:0xf bank_mask:0xf
  v_and_b32_dpp v19, v34, v5 row_newbcast:8 row_mask:0xf bank_mask:0xf
  v_mfma_f32_16x16x32_bf16 v[12:15], v[20:23], v[156:159], v[12:15]
  s_waitcnt vmcnt(2)
  s_add_u32 s58, s57, 1441792
  buffer_load_dwordx4 v[40:43], v1, s[32:35], s58 offen offset:1024 nt
  v_and_b32_dpp v20, v34, v2 row_newbcast:12 row_mask:0xf bank_mask:0xf
  v_and_b32_dpp v21, v34, v3 row_newbcast:12 row_mask:0xf bank_mask:0xf
  v_and_b32_dpp v22, v34, v4 row_newbcast:12 row_mask:0xf bank_mask:0xf
  v_and_b32_dpp v23, v34, v5 row_newbcast:12 row_mask:0xf bank_mask:0xf
  v_mfma_f32_16x16x32_bf16 v[12:15], v[16:19], v[108:111], v[12:15]
  s_waitcnt vmcnt(2)
  s_add_u32 s58, s57, 1441792
  buffer_load_dwordx4 v[148:151], v1, s[32:35], s58 offen offset:2048 nt
  v_and_b32_dpp v16, v35, v2 row_newbcast:0 row_mask:0xf bank_mask:0xf
  v_and_b32_dpp v17, v35, v3 row_newbcast:0 row_mask:0xf bank_mask:0xf
  v_and_b32_dpp v18, v35, v4 row_newbcast:0 row_mask:0xf bank_mask:0xf
  v_and_b32_dpp v19, v35, v5 row_newbcast:0 row_mask:0xf bank_mask:0xf
  v_mfma_f32_16x16x32_bf16 v[12:15], v[20:23], v[112:115], v[12:15]
  s_waitcnt vmcnt(2)
  s_add_u32 s58, s57, 1441792
  buffer_load_dwordx4 v[28:31], v1, s[32:35], s58 offen offset:3072 nt
  v_and_b32_dpp v20, v35, v2 row_newbcast:4 row_mask:0xf bank_mask:0xf
  v_and_b32_dpp v21, v35, v3 row_newbcast:4 row_mask:0xf bank_mask:0xf
  v_and_b32_dpp v22, v35, v4 row_newbcast:4 row_mask:0xf bank_mask:0xf
  v_and_b32_dpp v23, v35, v5 row_newbcast:4 row_mask:0xf bank_mask:0xf
  v_mfma_f32_16x16x32_bf16 v[12:15], v[16:19], v[24:27], v[12:15]
  s_waitcnt vmcnt(2)
  s_add_u32 s58, s57, 1572864
  buffer_load_dwordx4 v[76:79], v1, s[32:35], s58 offen offset:0 nt
  v_and_b32_dpp v16, v35, v2 row_newbcast:8 row_mask:0xf bank_mask:0xf
  v_and_b32_dpp v17, v35, v3 row_newbcast:8 row_mask:0xf bank_mask:0xf
  v_and_b32_dpp v18, v35, v4 row_newbcast:8 row_mask:0xf bank_mask:0xf
  v_and_b32_dpp v19, v35, v5 row_newbcast:8 row_mask:0xf bank_mask:0xf
  v_mfma_f32_16x16x32_bf16 v[12:15], v[20:23], v[40:43], v[12:15]
  s_waitcnt vmcnt(2)
  s_add_u32 s58, s57, 1572864
  buffer_load_dwordx4 v[156:159], v1, s[32:35], s58 offen offset:1024 nt
  v_and_b32_dpp v20, v35, v2 row_newbcast:12 row_mask:0xf bank_mask:0xf
  v_and_b32_dpp v21, v35, v3 row_newbcast:12 row_mask:0xf bank_mask:0xf
  v_and_b32_dpp v22, v35, v4 row_newbcast:12 row_mask:0xf bank_mask:0xf
  v_and_b32_dpp v23, v35, v5 row_newbcast:12 row_mask:0xf bank_mask:0xf
  v_mfma_f32_16x16x32_bf16 v[12:15], v[16:19], v[148:151], v[12:15]
  s_waitcnt vmcnt(2)
  s_add_u32 s58, s57, 1572864
  buffer_load_dwordx4 v[108:111], v1, s[32:35], s58 offen offset:2048 nt
  v_and_b32_dpp v16, v36, v2 row_newbcast:0 row_mask:0xf bank_mask:0xf
  v_and_b32_dpp v17, v36, v3 row_newbcast:0 row_mask:0xf bank_mask:0xf
  v_and_b32_dpp v18, v36, v4 row_newbcast:0 row_mask:0xf bank_mask:0xf
  v_and_b32_dpp v19, v36, v5 row_newbcast:0 row_mask:0xf bank_mask:0xf
  v_mfma_f32_16x16x32_bf16 v[12:15], v[20:23], v[28:31], v[12:15]
  s_waitcnt vmcnt(2)
  s_add_u32 s58, s57, 1572864
  buffer_load_dwordx4 v[112:115], v1, s[32:35], s58 offen offset:3072 nt
  v_and_b32_dpp v20, v36, v2 row_newbcast:4 row_mask:0xf bank_mask:0xf
  v_and_b32_dpp v21, v36, v3 row_newbcast:4 row_mask:0xf bank_mask:0xf
  v_and_b32_dpp v22, v36, v4 row_newbcast:4 row_mask:0xf bank_mask:0xf
  v_and_b32_dpp v23, v36, v5 row_newbcast:4 row_mask:0xf bank_mask:0xf
  v_mfma_f32_16x16x32_bf16 v[12:15], v[16:19], v[76:79], v[12:15]
  s_waitcnt vmcnt(2)
  s_add_u32 s58, s57, 1703936
  buffer_load_dwordx4 v[24:27], v1, s[32:35], s58 offen offset:0 nt
  v_and_b32_dpp v16, v36, v2 row_newbcast:8 row_mask:0xf bank_mask:0xf
  v_and_b32_dpp v17, v36, v3 row_newbcast:8 row_mask:0xf bank_mask:0xf
  v_and_b32_dpp v18, v36, v4 row_newbcast:8 row_mask:0xf bank_mask:0xf
  v_and_b32_dpp v19, v36, v5 row_newbcast:8 row_mask:0xf bank_mask:0xf
  v_mfma_f32_16x16x32_bf16 v[12:15], v[20:23], v[156:159], v[12:15]
  s_waitcnt vmcnt(2)
  s_add_u32 s58, s57, 1703936
  buffer_load_dwordx4 v[40:43], v1, s[32:35], s58 offen offset:1024 nt
  v_and_b32_dpp v20, v36, v2 row_newbcast:12 row_mask:0xf bank_mask:0xf
  v_and_b32_dpp v21, v36, v3 row_newbcast:12 row_mask:0xf bank_mask:0xf
  v_and_b32_dpp v22, v36, v4 row_newbcast:12 row_mask:0xf bank_mask:0xf
  v_and_b32_dpp v23, v36, v5 row_newbcast:12 row_mask:0xf bank_mask:0xf
  v_mfma_f32_16x16x32_bf16 v[12:15], v[16:19], v[108:111], v[12:15]
  s_waitcnt vmcnt(2)
  s_add_u32 s58, s57, 1703936
  buffer_load_dwordx4 v[148:151], v1, s[32:35], s58 offen offset:2048 nt
  v_and_b32_dpp v16, v37, v2 row_newbcast:0 row_mask:0xf bank_mask:0xf
  v_and_b32_dpp v17, v37, v3 row_newbcast:0 row_mask:0xf bank_mask:0xf
  v_and_b32_dpp v18, v37, v4 row_newbcast:0 row_mask:0xf bank_mask:0xf
  v_and_b32_dpp v19, v37, v5 row_newbcast:0 row_mask:0xf bank_mask:0xf
  v_mfma_f32_16x16x32_bf16 v[12:15], v[20:23], v[112:115], v[12:15]
  s_waitcnt vmcnt(2)
  s_add_u32 s58, s57, 1703936
  buffer_load_dwordx4 v[28:31], v1, s[32:35], s58 offen offset:3072 nt
  v_and_b32_dpp v20, v37, v2 row_newbcast:4 row_mask:0xf bank_mask:0xf
  v_and_b32_dpp v21, v37, v3 row_newbcast:4 row_mask:0xf bank_mask:0xf
  v_and_b32_dpp v22, v37, v4 row_newbcast:4 row_mask:0xf bank_mask:0xf
  v_and_b32_dpp v23, v37, v5 row_newbcast:4 row_mask:0xf bank_mask:0xf
  v_mfma_f32_16x16x32_bf16 v[12:15], v[16:19], v[24:27], v[12:15]
  v_mov_b32 v6, 0
L_cw_5:
  ds_read_b32 v11, v6 offset:13072
  s_waitcnt lgkmcnt(0)
  v_cmp_eq_u32 vcc, 0, v11
  s_cbranch_vccz L_cok_6
  s_add_u32 s59, s59, 1
  s_cmp_gt_u32 s59, 4000000
  s_cbranch_scc1 L_cok_6
  s_sleep 4
  s_branch L_cw_5
L_cok_6:
  s_mov_b32 s59, 0
  s_lshl_b32 s56, s3, 2
  v_mov_b32 v11, s56
  ds_read_b32 v164, v11 offset:13184
  v_bfe_u32 v10, v0, 1, 3
  v_lshlrev_b32 v10, 6, v10
  v_and_b32 v11, 1, v0
  v_lshl_add_u32 v10, v11, 3, v10
  v_bfe_u32 v11, v0, 4, 1
  v_lshl_add_u32 v10, v11, 2, v10
  s_lshl_b32 s56, s3, 9
  v_add_u32 v10, s56, v10
  v_lshrrev_b32 v11, 4, v0
  v_lshlrev_b32 v11, 4, v11
  s_lshl_b32 s56, s3, 6
  v_add_u32 v11, s56, v11
  v_and_b32 v165, 8, v0
  v_cmp_eq_u32 vcc, 0, v165
  s_mul_i32 s56, s3, 5120
  v_add_u32 v166, s56, v166
  v_cndmask_b32 v6, 0, v2, vcc
  v_cndmask_b32 v7, 0, v3, vcc
  v_cndmask_b32 v8, 0, v4, vcc
  v_cndmask_b32 v9, 0, v5, vcc
  s_mul_i32 s56, s3, 24
  v_add_u32 v165, s56, v0
  v_lshlrev_b32 v167, 4, v165
  v_lshlrev_b32 v165, 2, v165
  v_lshlrev_b32 v1, 4, v0
  s_mul_i32 s84, s60, 3072
  s_add_u32 s84, s84, 1048576
  s_waitcnt lgkmcnt(0)
  s_waitcnt vmcnt(2)
  s_add_u32 s58, s57, 1835008
  buffer_load_dwordx4 v[32:35], v1, s[32:35], s58 offen offset:0 nt
  v_and_b32_dpp v16, v37, v2 row_newbcast:8 row_mask:0xf bank_mask:0xf
  v_and_b32_dpp v17, v37, v3 row_newbcast:8 row_mask:0xf bank_mask:0xf
  v_and_b32_dpp v18, v37, v4 row_newbcast:8 row_mask:0xf bank_mask:0xf
  v_and_b32_dpp v19, v37, v5 row_newbcast:8 row_mask:0xf bank_mask:0xf
  v_mfma_f32_16x16x32_bf16 v[12:15], v[20:23], v[40:43], v[12:15]
  s_waitcnt vmcnt(2)
  s_add_u32 s58, s57, 1835008
  buffer_load_dwordx4 v[76:79], v1, s[32:35], s58 offen offset:1024 nt
  v_and_b32_dpp v20, v37, v2 row_newbcast:12 row_mask:0xf bank_mask:0xf
  v_and_b32_dpp v21, v37, v3 row_newbcast:12 row_mask:0xf bank_mask:0xf
  v_and_b32_dpp v22, v37, v4 row_newbcast:12 row_mask:0xf bank_mask:0xf
  v_and_b32_dpp v23, v37, v5 row_newbcast:12 row_mask:0xf bank_mask:0xf
  v_mfma_f32_16x16x32_bf16 v[12:15], v[16:19], v[148:151], v[12:15]
  s_waitcnt vmcnt(2)
  s_add_u32 s58, s57, 1835008
  buffer_load_dwordx4 v[156:159], v1, s[32:35], s58 offen offset:2048 nt
  v_and_b32_dpp v16, v38, v2 row_newbcast:0 row_mask:0xf bank_mask:0xf
  v_and_b32_dpp v17, v38, v3 row_newbcast:0 row_mask:0xf bank_mask:0xf
  v_and_b32_dpp v18, v38, v4 row_newbcast:0 row_mask:0xf bank_mask:0xf
  v_and_b32_dpp v19, v38, v5 row_newbcast:0 row_mask:0xf bank_mask:0xf
  v_mfma_f32_16x16x32_bf16 v[12:15], v[20:23], v[28:31], v[12:15]
  s_waitcnt vmcnt(2)
  s_add_u32 s58, s57, 1835008
  buffer_load_dwordx4 v[108:111], v1, s[32:35], s58 offen offset:3072 nt
  v_and_b32_dpp v20, v38, v2 row_newbcast:4 row_mask:0xf bank_mask:0xf
  v_and_b32_dpp v21, v38, v3 row_newbcast:4 row_mask:0xf bank_mask:0xf
  v_and_b32_dpp v22, v38, v4 row_newbcast:4 row_mask:0xf bank_mask:0xf
  v_and_b32_dpp v23, v38, v5 row_newbcast:4 row_mask:0xf bank_mask:0xf
  v_mfma_f32_16x16x32_bf16 v[12:15], v[16:19], v[32:35], v[12:15]
  s_waitcnt vmcnt(2)
  s_add_u32 s58, s57, 1966080
  buffer_load_dwordx4 v[112:115], v1, s[32:35], s58 offen offset:0 nt
  v_and_b32_dpp v16, v38, v2 row_newbcast:8 row_mask:0xf bank_mask:0xf
  v_and_b32_dpp v17, v38, v3 row_newbcast:8 row_mask:0xf bank_mask:0xf
  v_and_b32_dpp v18, v38, v4 row_newbcast:8 row_mask:0xf bank_mask:0xf
  v_and_b32_dpp v19, v38, v5 row_newbcast:8 row_mask:0xf bank_mask:0xf
  v_mfma_f32_16x16x32_bf16 v[12:15], v[20:23], v[76:79], v[12:15]
  s_waitcnt vmcnt(2)
  s_add_u32 s58, s57, 1966080
  buffer_load_dwordx4 v[24:27], v1, s[32:35], s58 offen offset:1024 nt
  v_and_b32_dpp v20, v38, v2 row_newbcast:12 row_mask:0xf bank_mask:0xf
  v_and_b32_dpp v21, v38, v3 row_newbcast:12 row_mask:0xf bank_mask:0xf
  v_and_b32_dpp v22, v38, v4 row_newbcast:12 row_mask:0xf bank_mask:0xf
  v_and_b32_dpp v23, v38, v5 row_newbcast:12 row_mask:0xf bank_mask:0xf
  v_mfma_f32_16x16x32_bf16 v[12:15], v[16:19], v[156:159], v[12:15]
  s_waitcnt vmcnt(2)
  s_add_u32 s58, s57, 1966080
  buffer_load_dwordx4 v[40:43], v1, s[32:35], s58 offen offset:2048 nt
  v_and_b32_dpp v16, v39, v2 row_newbcast:0 row_mask:0xf bank_mask:0xf
  v_and_b32_dpp v17, v39, v3 row_newbcast:0 row_mask:0xf bank_mask:0xf
  v_and_b32_dpp v18, v39, v4 row_newbcast:0 row_mask:0xf bank_mask:0xf
  v_and_b32_dpp v19, v39, v5 row_newbcast:0 row_mask:0xf bank_mask:0xf
  v_mfma_f32_16x16x32_bf16 v[12:15], v[20:23], v[108:111], v[12:15]
  s_waitcnt vmcnt(2)
  s_add_u32 s58, s57, 1966080
  buffer_load_dwordx4 v[148:151], v1, s[32:35], s58 offen offset:3072 nt
  v_and_b32_dpp v20, v39, v2 row_newbcast:4 row_mask:0xf bank_mask:0xf
  v_and_b32_dpp v21, v39, v3 row_newbcast:4 row_mask:0xf bank_mask:0xf
  v_and_b32_dpp v22, v39, v4 row_newbcast:4 row_mask:0xf bank_mask:0xf
  v_and_b32_dpp v23, v39, v5 row_newbcast:4 row_mask:0xf bank_mask:0xf
  v_mfma_f32_16x16x32_bf16 v[12:15], v[16:19], v[112:115], v[12:15]
  v_and_b32_dpp v16, v39, v2 row_newbcast:8 row_mask:0xf bank_mask:0xf
  v_and_b32_dpp v17, v39, v3 row_newbcast:8 row_mask:0xf bank_mask:0xf
  v_and_b32_dpp v18, v39, v4 row_newbcast:8 row_mask:0xf bank_mask:0xf
  v_and_b32_dpp v19, v39, v5 row_newbcast:8 row_mask:0xf bank_mask:0xf
  s_waitcnt vmcnt(2)
  v_mfma_f32_16x16x32_bf16 v[12:15], v[20:23], v[24:27], v[12:15]
  v_and_b32_dpp v20, v39, v2 row_newbcast:12 row_mask:0xf bank_mask:0xf
  v_and_b32_dpp v21, v39, v3 row_newbcast:12 row_mask:0xf bank_mask:0xf
  v_and_b32_dpp v22, v39, v4 row_newbcast:12 row_mask:0xf bank_mask:0xf
  v_and_b32_dpp v23, v39, v5 row_newbcast:12 row_mask:0xf bank_mask:0xf
  s_waitcnt vmcnt(1)
  v_mfma_f32_16x16x32_bf16 v[12:15], v[16:19], v[40:43], v[12:15]
  s_nop 1
  s_waitcnt vmcnt(0)
  v_mfma_f32_16x16x32_bf16 v[12:15], v[20:23], v[148:151], v[12:15]
  s_nop 7
  v_mul_f32 v12, v12, v164
  v_mul_f32 v13, v13, v164
  v_mul_f32 v14, v14, v164
  v_mul_f32 v15, v15, v164
  ds_write_b32 v10, v12 offset:4096
  ds_write_b32 v10, v13 offset:4112
  ds_write_b32 v10, v14 offset:4128
  ds_write_b32 v10, v15 offset:4144
  s_waitcnt lgkmcnt(0)
  s_barrier
  ds_read_b128 v[36:39], v11 offset:4096
  ds_read_b128 v[28:31], v11 offset:4608
  ds_read_b128 v[32:35], v11 offset:5120
  ds_read_b128 v[76:79], v11 offset:5632
  ds_read_b128 v[156:159], v11 offset:6144
  ds_read_b128 v[108:111], v11 offset:6656
  ds_read_b128 v[112:115], v11 offset:7168
  ds_read_b128 v[24:27], v11 offset:7680
  s_waitcnt lgkmcnt(6)
  v_add_f32 v36, v36, v28
  v_add_f32 v37, v37, v29
  v_add_f32 v38, v38, v30
  v_add_f32 v39, v39, v31
  s_waitcnt lgkmcnt(5)
  v_add_f32 v36, v36, v32
  v_add_f32 v37, v37, v33
  v_add_f32 v38, v38, v34
  v_add_f32 v39, v39, v35
  s_waitcnt lgkmcnt(4)
  v_add_f32 v36, v36, v76
  v_add_f32 v37, v37, v77
  v_add_f32 v38, v38, v78
  v_add_f32 v39, v39, v79
  s_waitcnt lgkmcnt(3)
  v_add_f32 v36, v36, v156
  v_add_f32 v37, v37, v157
  v_add_f32 v38, v38, v158
  v_add_f32 v39, v39, v159
  s_waitcnt lgkmcnt(2)
  v_add_f32 v36, v36, v108
  v_add_f32 v37, v37, v109
  v_add_f32 v38, v38, v110
  v_add_f32 v39, v39, v111
  s_waitcnt lgkmcnt(1)
  v_add_f32 v36, v36, v112
  v_add_f32 v37, v37, v113
  v_add_f32 v38, v38, v114
  v_add_f32 v39, v39, v115
  s_waitcnt lgkmcnt(0)
  v_add_f32 v36, v36, v24
  v_add_f32 v37, v37, v25
  v_add_f32 v38, v38, v26
  v_add_f32 v39, v39, v27
  v_cvt_pk_bf16_f32 v36, v36, v36
  v_cvt_pk_bf16_f32 v37, v37, v37
  v_cvt_pk_bf16_f32 v38, v38, v38
  v_cvt_pk_bf16_f32 v39, v39, v39
  v_and_b32 v16, v36, v6
  v_and_b32 v17, v36, v7
  v_and_b32 v18, v36, v8
  v_and_b32 v19, v36, v9
  s_nop 1
  v_mfma_f32_16x16x32_bf16 v[60:63], v[16:19], v[100:103], v[60:63]
  v_mfma_f32_16x16x32_bf16 v[84:87], v[16:19], v[144:147], v[84:87]
  v_mfma_f32_16x16x32_bf16 v[160:163], v[16:19], v[44:47], v[160:163]
  v_mfma_f32_16x16x32_bf16 v[132:135], v[16:19], v[56:59], v[132:135]
  v_mfma_f32_16x16x32_bf16 v[124:127], v[16:19], v[68:71], v[124:127]
  v_and_b32 v20, v37, v6
  v_and_b32 v21, v37, v7
  v_and_b32 v22, v37, v8
  v_and_b32 v23, v37, v9
  s_nop 1
  v_mfma_f32_16x16x32_bf16 v[60:63], v[20:23], v[80:83], v[60:63]
  v_mfma_f32_16x16x32_bf16 v[84:87], v[20:23], v[92:95], v[84:87]
  v_mfma_f32_16x16x32_bf16 v[160:163], v[20:23], v[152:155], v[160:163]
  v_mfma_f32_16x16x32_bf16 v[132:135], v[20:23], v[128:131], v[132:135]
  v_mfma_f32_16x16x32_bf16 v[124:127], v[20:23], v[116:119], v[124:127]
  v_and_b32 v16, v38, v6
  v_and_b32 v17, v38, v7
  v_and_b32 v18, v38, v8
  v_and_b32 v19, v38, v9
  s_nop 1
  v_mfma_f32_16x16x32_bf16 v[60:63], v[16:19], v[104:107], v[60:63]
  v_mfma_f32_16x16x32_bf16 v[84:87], v[16:19], v[140:143], v[84:87]
  v_mfma_f32_16x16x32_bf16 v[160:163], v[16:19], v[52:55], v[160:163]
  v_mfma_f32_16x16x32_bf16 v[132:135], v[16:19], v[72:75], v[132:135]
  v_mfma_f32_16x16x32_bf16 v[124:127], v[16:19], v[88:91], v[124:127]
  v_and_b32 v20, v39, v6
  v_and_b32 v21, v39, v7
  v_and_b32 v22, v39, v8
  v_and_b32 v23, v39, v9
  s_nop 1
  v_mfma_f32_16x16x32_bf16 v[60:63], v[20:23], v[136:139], v[60:63]
  v_mfma_f32_16x16x32_bf16 v[84:87], v[20:23], v[120:123], v[84:87]
  v_mfma_f32_16x16x32_bf16 v[160:163], v[20:23], v[96:99], v[160:163]
  v_mfma_f32_16x16x32_bf16 v[132:135], v[20:23], v[48:51], v[132:135]
  v_mfma_f32_16x16x32_bf16 v[124:127], v[20:23], v[64:67], v[124:127]
  s_nop 3
  s_mov_b32 exec_hi, 0
  ds_write_b128 v166, v[60:63] offset:13312
  ds_write_b128 v166, v[84:87] offset:13824
  ds_write_b128 v166, v[160:163] offset:14336
  ds_write_b128 v166, v[132:135] offset:14848
  s_nop 3
  ds_write_b128 v166, v[124:127] offset:15360
  s_waitcnt lgkmcnt(0)
  s_barrier
  s_mov_b32 exec_lo, 0xffffff
  ds_read_b32 v36, v165 offset:13312
  ds_read_b32 v37, v165 offset:14080
  ds_read_b32 v38, v165 offset:14848
  ds_read_b32 v28, v165 offset:18432
  ds_read_b32 v29, v165 offset:19200
  ds_read_b32 v30, v165 offset:19968
  ds_read_b32 v32, v165 offset:23552
  ds_read_b32 v33, v165 offset:24320
  ds_read_b32 v34, v165 offset:25088
  ds_read_b32 v76, v165 offset:28672
  ds_read_b32 v77, v165 offset:29440
  ds_read_b32 v78, v165 offset:30208
  ds_read_b32 v156, v165 offset:33792
  ds_read_b32 v157, v165 offset:34560
  ds_read_b32 v158, v165 offset:35328
  s_waitcnt lgkmcnt(3)
  v_add_f32 v36, v36, v28
  v_add_f32 v37, v37, v29
  v_add_f32 v38, v38, v30
  v_add_f32 v36, v36, v32
  v_add_f32 v37, v37, v33
  v_add_f32 v38, v38, v34
  v_add_f32 v36, v36, v76
  v_add_f32 v37, v37, v77
  v_add_f32 v38, v38, v78
  ds_read_b32 v108, v165 offset:38912
  ds_read_b32 v109, v165 offset:39680
  ds_read_b32 v110, v165 offset:40448
  ds_read_b32 v112, v165 offset:44032
  ds_read_b32 v113, v165 offset:44800
  ds_read_b32 v114, v165 offset:45568
  ds_read_b32 v24, v165 offset:49152
  ds_read_b32 v25, v165 offset:49920
  ds_read_b32 v26, v165 offset:50688
  ds_read_b32 v40, v165 offset:54272
  ds_read_b32 v41, v165 offset:55040
  ds_read_b32 v42, v165 offset:55808
  s_waitcnt lgkmcnt(12)
  v_add_f32 v36, v36, v156
  v_add_f32 v37, v37, v157
  v_add_f32 v38, v38, v158
  s_waitcnt lgkmcnt(9)
  v_add_f32 v36, v36, v108
  v_add_f32 v37, v37, v109
  v_add_f32 v38, v38, v110
  s_waitcnt lgkmcnt(6)
  v_add_f32 v36, v36, v112
  v_add_f32 v37, v37, v113
  v_add_f32 v38, v38, v114
  s_waitcnt lgkmcnt(3)
  v_add_f32 v36, v36, v24
  v_add_f32 v37, v37, v25
  v_add_f32 v38, v38, v26
  s_waitcnt lgkmcnt(0)
  v_add_f32 v36, v36, v40
  v_add_f32 v37, v37, v41
  v_add_f32 v38, v38, v42
  v_add3_u32 v39, v36, v37, v38
  v_add_u32 v39, s87, v39
  buffer_store_dwordx4 v[36:39], v167, s[44:47], s84 offen sc1
  s_endpgm
L_aux:
  s_setprio 3
  v_mov_b32 v4, 0
  v_mov_b32 v5, 0
  v_mov_b32 v6, 0
  v_mov_b32 v7, 0
  ds_write_b128 v4, v[4:7] offset:13056
  ds_write_b128 v4, v[4:7] offset:13072
  s_waitcnt lgkmcnt(0)
  s_barrier
  s_add_u32 s62, s26, 3342400
  s_addc_u32 s63, s27, 0
  s_load_dword s87, s[62:63], 0
  v_lshlrev_b32 v1, 4, v0
  s_waitcnt lgkmcnt(0)
  s_add_u32 s87, s87, 1
  v_mov_b32 v3, s87
  ds_write_b32 v4, v3 offset:12544
  s_lshl_b32 s56, s2, 11
  s_add_u32 s56, s56, 2752512
  v_lshlrev_b32 v2, 5, v0
L_pw_7:
  ds_read_b32 v5, v4 offset:13056
  s_waitcnt lgkmcnt(0)
  v_cmp_ne_u32 vcc, 8, v5
  s_cbranch_vccz L_pok_8
  s_add_u32 s59, s59, 1
  s_cmp_gt_u32 s59, 4000000
  s_cbranch_scc1 L_pok_8
  s_sleep 1
  s_branch L_pw_7
L_pok_8:
  s_mov_b32 s59, 0
  ds_read_b128 v[8:11], v1 offset:4096
  ds_read_b128 v[12:15], v1 offset:5120
  ds_read_b128 v[16:19], v1 offset:6144
  ds_read_b128 v[20:23], v1 offset:7168
  ds_read_b128 v[24:27], v1 offset:8192
  ds_read_b128 v[28:31], v1 offset:9216
  ds_read_b128 v[32:35], v1 offset:10240
  ds_read_b128 v[36:39], v1 offset:11264
  s_waitcnt lgkmcnt(6)
  v_add_f32 v8, v8, v12
  v_add_f32 v9, v9, v13
  v_add_f32 v10, v10, v14
  v_add_f32 v11, v11, v15
  s_waitcnt lgkmcnt(5)
  v_add_f32 v8, v8, v16
  v_add_f32 v9, v9, v17
  v_add_f32 v10, v10, v18
  v_add_f32 v11, v11, v19
  s_waitcnt lgkmcnt(4)
  v_add_f32 v8, v8, v20
  v_add_f32 v9, v9, v21
  v_add_f32 v10, v10, v22
  v_add_f32 v11, v11, v23
  s_waitcnt lgkmcnt(3)
  v_add_f32 v8, v8, v24
  v_add_f32 v9, v9, v25
  v_add_f32 v10, v10, v26
  v_add_f32 v11, v11, v27
  s_waitcnt lgkmcnt(2)
  v_add_f32 v8, v8, v28
  v_add_f32 v9, v9, v29
  v_add_f32 v10, v10, v30
  v_add_f32 v11, v11, v31
  s_waitcnt lgkmcnt(1)
  v_add_f32 v8, v8, v32
  v_add_f32 v9, v9, v33
  v_add_f32 v10, v10, v34
  v_add_f32 v11, v11, v35
  s_waitcnt lgkmcnt(0)
  v_add_f32 v8, v8, v36
  v_add_f32 v9, v9, v37
  v_add_f32 v10, v10, v38
  v_add_f32 v11, v11, v39
  v_mov_b32 v12, v10
  v_mov_b32 v14, v11
  v_mov_b32 v10, v9
  v_add_u32 v9, v3, v8
  v_add_u32 v11, v3, v10
  v_add_u32 v13, v3, v12
  v_add_u32 v15, v3, v14
  buffer_store_dwordx4 v[8:11], v2, s[44:47], s56 offen sc1
  buffer_store_dwordx4 v[12:15], v2, s[44:47], s56 offen offset:16 sc1
  v_lshrrev_b32 v5, 5, v0
  v_lshlrev_b32 v5, 11, v5
  v_and_b32 v6, 31, v0
  v_lshl_add_u32 v5, v6, 5, v5
  s_lshl_b32 s56, s52, 12
  s_lshl_b32 s58, s53, 10
  s_add_u32 s56, s56, s58
  s_add_u32 s56, s56, 2752512
L_qlp_10:
  buffer_load_dwordx4 v[16:19], v5, s[44:47], s56 offen sc1
  buffer_load_dwordx4 v[20:23], v5, s[44:47], s56 offen offset:16 sc1
  s_waitcnt vmcnt(0)
  v_add_u32 v8, v3, v16
  v_xor_b32 v8, v8, v17
  v_add_u32 v9, v3, v18
  v_xor_b32 v9, v9, v19
  v_add_u32 v10, v3, v20
  v_xor_b32 v10, v10, v21
  v_add_u32 v11, v3, v22
  v_xor_b32 v11, v11, v23
  v_or3_b32 v7, v8, v9, v10
  v_or_b32 v7, v7, v11
  v_cmp_ne_u32 vcc, 0, v7
  s_cbranch_vccz L_qok_9
  s_add_u32 s59, s59, 1
  s_cmp_gt_u32 s59, 200000
  s_cbranch_scc1 L_qok_9
  s_sleep 2
  s_branch L_qlp_10
L_qok_9:
  v_lshlrev_b32 v6, 3, v6
  v_mov_b32 v8, v16
  v_mov_b32 v12, v16
  v_mov_b32 v9, v18
  v_mov_b32 v13, v18
  v_mov_b32 v10, v20
  v_mov_b32 v14, v20
  v_mov_b32 v11, v22
  v_mov_b32 v15, v22
  s_nop 1
  v_permlane32_swap_b32 v8, v12
  v_permlane32_swap_b32 v9, v13
  v_permlane32_swap_b32 v10, v14
  v_permlane32_swap_b32 v11, v15
  s_nop 1
  v_add_f32 v8, v8, v12
  v_add_f32 v9, v9, v13
  v_add_f32 v10, v10, v14
  v_add_f32 v11, v11, v15
  v_cvt_pk_bf16_f32 v8, v8, v9
  v_cvt_pk_bf16_f32 v9, v10, v11
  ds_write_b64 v6, v[8:9] offset:12288
  v_mov_b32 v5, 1
  s_waitcnt lgkmcnt(0)
  ds_write_b32 v4, v5 offset:13060
  s_mov_b32 s36, s20
  s_mov_b32 s37, s21
  s_mov_b32 s38, 0x00510000
  s_mov_b32 s39, 0x20000
  v_lshrrev_b32 v5, 4, v0
  v_mul_u32_u24 v5, 1152, v5
  v_and_b32 v6, 15, v0
  v_lshl_add_u32 v5, v6, 4, v5
  s_add_u32 s56, s88, 32
  s_mul_i32 s56, s56, 1152
  buffer_load_dwordx4 v[56:59], v5, s[36:39], s56 offen offset:0
  buffer_load_dwordx4 v[60:63], v5, s[36:39], s56 offen offset:256
  buffer_load_dwordx4 v[64:67], v5, s[36:39], s56 offen offset:512
  buffer_load_dwordx4 v[68:71], v5, s[36:39], s56 offen offset:768
  buffer_load_dwordx4 v[72:75], v5, s[36:39], s56 offen offset:1024
  v_min_u32 v5, 35, v0
  v_add_u32 v5, s88, v5
  v_lshrrev_b32 v6, 7, v5
  v_lshlrev_b32 v6, 12, v6
  v_and_b32 v5, 127, v5
  v_lshl_add_u32 v5, v5, 3, v6
  s_lshl_b32 s56, s53, 10
  s_add_u32 s56, s56, 2883584
  s_add_u32 s58, s56, 147456
  v_and_b32 v44, 1, v0
  v_lshlrev_b32 v44, 4, v44
  v_mov_b32 v45, 0xffff
  v_lshlrev_b32 v45, v44, v45
  v_bfe_u32 v44, v0, 1, 2
  v_cmp_eq_u32 vcc, 0, v44
  s_nop 1
  v_cndmask_b32 v40, 0, v45, vcc
  v_cmp_eq_u32 vcc, 1, v44
  s_nop 1
  v_cndmask_b32 v41, 0, v45, vcc
  v_cmp_eq_u32 vcc, 2, v44
  s_nop 1
  v_cndmask_b32 v42, 0, v45, vcc
  v_cmp_eq_u32 vcc, 3, v44
  s_nop 1
  v_cndmask_b32 v43, 0, v45, vcc
L_dlp_12:
  buffer_load_dwordx2 v[48:49], v5, s[44:47], s56 offen offset:0 sc1
  buffer_load_dwordx2 v[50:51], v5, s[44:47], s56 offen offset:2048 sc1
  buffer_load_dwordx2 v[52:53], v5, s[44:47], s58 offen offset:0 sc1
  buffer_load_dwordx2 v[54:55], v5, s[44:47], s58 offen offset:2048 sc1
  s_waitcnt vmcnt(0)
  v_add_u32 v44, v3, v48
  v_xor_b32 v44, v44, v49
  v_add_u32 v45, v3, v50
  v_xor_b32 v45, v45, v51
  v_add_u32 v46, v3, v52
  v_xor_b32 v46, v46, v53
  v_add_u32 v47, v3, v54
  v_xor_b32 v47, v47, v55
  v_or3_b32 v44, v44, v45, v46
  v_or_b32 v44, v44, v47
  v_cmp_ne_u32 vcc, 0, v44
  s_cbranch_vccz L_dok_11
  s_add_u32 s59, s59, 1
  s_cmp_gt_u32 s59, 200000
  s_cbranch_scc1 L_dok_11
  s_sleep 8
  s_branch L_dlp_12
L_dok_11:
  s_mov_b32 s56, 0x3d372713
  v_add_f32 v48, v48, v50
  v_add_f32 v52, v52, v54
  v_cvt_pk_bf16_f32 v48, v48, v48
  v_and_b32 v48, 0xffff0000, v48
  v_cvt_pk_bf16_f32 v52, v52, v52
  v_and_b32 v52, 0xffff0000, v52
  v_mul_f32 v49, v48, v48
  v_fma_f32 v49, v49, s56, 1.0
  v_mul_f32 v49, v49, v48
  v_mul_f32 v49, 0xc0135761, v49
  v_exp_f32 v49, v49
  s_nop 0
  v_add_f32 v49, 1.0, v49
  v_rcp_f32 v49, v49
  s_nop 0
  v_mul_f32 v49, v49, v48
  v_cvt_pk_bf16_f32 v49, v49, v49
  v_and_b32 v49, 0xffff0000, v49
  v_mul_f32 v49, v49, v52
  v_cvt_pk_bf16_f32 v49, v49, v49
  v_lshlrev_b32 v5, 2, v0
  ds_write_b32 v5, v49 offset:12800
  v_mov_b32 v6, 1
  v_lshrrev_b32 v5, 4, v0
  v_lshlrev_b32 v5, 2, v5
  s_waitcnt lgkmcnt(0)
  ds_write_b32 v4, v6 offset:13064
  ds_read_b32 v5, v5 offset:12928
  v_and_b32 v6, 8, v0
  v_cmp_eq_u32 vcc, 0, v6
  s_waitcnt lgkmcnt(0)
  s_nop 0
  v_cndmask_b32 v5, 0, v5, vcc
  v_and_b32 v44, v5, v40
  v_and_b32 v45, v5, v41
  v_and_b32 v46, v5, v42
  v_and_b32 v47, v5, v43
  s_nop 1
  v_mfma_f32_16x16x32_bf16 v[76:79], v[44:47], v[56:59], 0
  v_mfma_f32_16x16x32_bf16 v[80:83], v[44:47], v[60:63], 0
  v_mfma_f32_16x16x32_bf16 v[84:87], v[44:47], v[64:67], 0
  v_mfma_f32_16x16x32_bf16 v[88:91], v[44:47], v[68:71], 0
  v_mfma_f32_16x16x32_bf16 v[92:95], v[44:47], v[72:75], 0
  v_and_b32 v5, 15, v0
  v_lshlrev_b32 v5, 5, v5
  v_and_b32 v6, 16, v0
  v_add_u32 v5, v5, v6
  v_lshrrev_b32 v6, 5, v0
  v_mul_u32_u24 v6, 2560, v6
  v_add_u32 v5, v5, v6
  s_nop 3
  ds_write_b128 v5, v[76:79] offset:54272
  ds_write_b128 v5, v[80:83] offset:54784
  ds_write_b128 v5, v[84:87] offset:55296
  ds_write_b128 v5, v[88:91] offset:55808
  ds_write_b128 v5, v[92:95] offset:56320
  s_waitcnt lgkmcnt(0)
  v_and_b32 v5, 7, v0
  v_lshlrev_b32 v5, 3, v5
  s_lshl_b32 s56, s55, 7
  s_add_u32 s56, s56, 2686976
  s_lshl_b32 s58, s54, 4
  v_mov_b32 v6, s58
  v_and_b32 v7, 3, v0
  v_lshlrev_b32 v7, 4, v7
L_kw_13:
  ds_read_b32 v8, v4 offset:13068
  s_waitcnt lgkmcnt(0)
  v_cmp_ne_u32 vcc, 8, v8
  s_cbranch_vccz L_kok_14
  s_add_u32 s59, s59, 1
  s_cmp_gt_u32 s59, 4000000
  s_cbranch_scc1 L_kok_14
  s_sleep 8
  s_branch L_kw_13
L_kok_14:
  s_mov_b32 s59, 0
  ds_read_b64 v[8:9], v5 offset:13120
  s_waitcnt lgkmcnt(0)
  v_mov_b32 v12, v8
  s_nop 1
  v_max_f32_dpp v12, v12, v12 quad_perm:[1,0,3,2] row_mask:0xf bank_mask:0xf
  s_nop 1
  v_max_f32_dpp v12, v12, v12 quad_perm:[2,3,0,1] row_mask:0xf bank_mask:0xf
  s_nop 1
  v_max_f32_dpp v12, v12, v12 row_half_mirror row_mask:0xf bank_mask:0xf
  v_sub_f32 v13, v8, v12
  v_exp_f32 v13, v13
  s_nop 0
  v_mul_f32 v13, v13, v9
  s_nop 1
  v_add_f32_dpp v13, v13, v13 quad_perm:[1,0,3,2] row_mask:0xf bank_mask:0xf
  s_nop 1
  v_add_f32_dpp v13, v13, v13 quad_perm:[2,3,0,1] row_mask:0xf bank_mask:0xf
  s_nop 1
  v_add_f32_dpp v13, v13, v13 row_half_mirror row_mask:0xf bank_mask:0xf
  v_mov_b32 v14, 0
  v_add3_u32 v15, v12, v13, v3
  s_mov_b64 exec, 1
  buffer_store_dwordx4 v[12:15], v6, s[44:47], s56 offen sc1
  s_mov_b64 exec, -1
L_mlp_16:
  buffer_load_dwordx4 v[16:19], v7, s[44:47], s56 offen sc1
  s_waitcnt vmcnt(0)
  v_add3_u32 v18, v16, v17, v3
  v_cmp_ne_u32 vcc, v18, v19
  s_cbranch_vccz L_mok_15
  s_add_u32 s59, s59, 1
  s_cmp_gt_u32 s59, 200000
  s_cbranch_scc1 L_mok_15
  s_sleep 32
  s_branch L_mlp_16
L_mok_15:
  v_mov_b32 v18, v16
  s_nop 1
  v_max_f32_dpp v18, v18, v18 quad_perm:[1,0,3,2] row_mask:0xf bank_mask:0xf
  s_nop 1
  v_max_f32_dpp v18, v18, v18 quad_perm:[2,3,0,1] row_mask:0xf bank_mask:0xf
  v_sub_f32 v16, v16, v18
  v_exp_f32 v16, v16
  v_sub_f32 v8, v8, v18
  v_exp_f32 v8, v8
  v_mul_f32 v16, v16, v17
  s_nop 1
  v_add_f32_dpp v16, v16, v16 quad_perm:[1,0,3,2] row_mask:0xf bank_mask:0xf
  s_nop 1
  v_add_f32_dpp v16, v16, v16 quad_perm:[2,3,0,1] row_mask:0xf bank_mask:0xf
  v_rcp_f32 v16, v16
  v_lshrrev_b32 v5, 1, v5
  v_mul_f32 v8, v8, v16
  v_mov_b32 v6, 1
  ds_write_b32 v5, v8 offset:13184
  s_waitcnt lgkmcnt(0)
  ds_write_b32 v4, v6 offset:13072
  s_waitcnt lgkmcnt(0)
  s_setprio 0
  s_cmp_lt_u32 s2, 96
  s_cbranch_scc1 L_fin
  s_cmp_lg_u32 s2, 255
  s_cbranch_scc1 L_end
  s_mov_b64 exec, -1
  v_lshlrev_b32 v5, 11, v0
  v_add_u32 v5, 2752512, v5
  s_mov_b32 s56, 131072
  s_mov_b32 s58, 262144
  s_mov_b32 s84, 393216
L_elp_18:
  buffer_load_dwordx2 v[8:9], v5, s[44:47], 0 offen sc1
  buffer_load_dwordx2 v[10:11], v5, s[44:47], s56 offen sc1
  buffer_load_dwordx2 v[12:13], v5, s[44:47], s58 offen sc1
  buffer_load_dwordx2 v[14:15], v5, s[44:47], s84 offen sc1
  s_waitcnt vmcnt(0)
  v_add_u32 v8, v3, v8
  v_xor_b32 v8, v8, v9
  v_add_u32 v10, v3, v10
  v_xor_b32 v10, v10, v11
  v_add_u32 v12, v3, v12
  v_xor_b32 v12, v12, v13
  v_add_u32 v14, v3, v14
  v_xor_b32 v14, v14, v15
  v_or3_b32 v7, v8, v10, v12
  v_or_b32 v7, v7, v14
  v_cmp_ne_u32 vcc, 0, v7
  s_cbranch_vccz L_eok_17
  s_add_u32 s59, s59, 1
  s_cmp_gt_u32 s59, 200000
  s_cbranch_scc1 L_eok_17
  s_sleep 64
  s_branch L_elp_18
L_eok_17:
  v_mov_b32 v2, 3342400
  s_mov_b64 exec, 1
  buffer_store_dword v3, v2, s[44:47], 0 offen sc1
  s_endpgm
L_fin:
  s_cmp_ge_u32 s2, 48
  s_cselect_b32 s53, 1, 0
  s_mul_i32 s56, s53, 48
  s_sub_u32 s52, s2, s56
  v_and_b32 v2, 3, v0
  v_lshrrev_b32 v4, 4, v0
  v_min_u32 v4, 2, v4
  v_mul_u32_u24 v4, 192, v4
  v_add_u32 v2, v2, v4
  s_mul_i32 s56, s53, 576
  s_lshl_b32 s58, s52, 2
  s_add_u32 s56, s56, s58
  v_add_u32 v2, s56, v2
  v_lshlrev_b32 v6, 1, v2
  global_load_ushort v7, v6, s[4:5]
  s_mul_i32 s57, s53, 393216
  s_lshl_b32 s56, s52, 6
  s_add_u32 s57, s57, s56
  s_add_u32 s57, s57, 1048576
  v_lshrrev_b32 v1, 2, v0
  v_mul_u32_u24 v1, 3072, v1
  v_and_b32 v2, 3, v0
  v_lshl_add_u32 v1, v2, 4, v1
  s_waitcnt vmcnt(0)
  v_lshlrev_b32 v7, 16, v7
  s_add_u32 s64, s57, 0
  s_add_u32 s65, s57, 49152
  s_add_u32 s66, s57, 98304
  s_add_u32 s67, s57, 147456
  s_add_u32 s68, s57, 196608
  s_add_u32 s69, s57, 245760
  s_add_u32 s70, s57, 294912
  s_add_u32 s71, s57, 344064
  s_mov_b32 s62, 0
  s_barrier
  s_barrier
  buffer_load_dwordx4 v[8:11], v1, s[44:47], s64 offen sc1
  buffer_load_dwordx4 v[12:15], v1, s[44:47], s65 offen sc1
  buffer_load_dwordx4 v[16:19], v1, s[44:47], s66 offen sc1
  buffer_load_dwordx4 v[20:23], v1, s[44:47], s67 offen sc1
  buffer_load_dwordx4 v[24:27], v1, s[44:47], s68 offen sc1
  buffer_load_dwordx4 v[28:31], v1, s[44:47], s69 offen sc1
  buffer_load_dwordx4 v[32:35], v1, s[44:47], s70 offen sc1
  buffer_load_dwordx4 v[36:39], v1, s[44:47], s71 offen sc1
L_ylp_19:
  s_waitcnt vmcnt(0)
  s_bitcmp1_b32 s62, 0
  s_cbranch_scc1 L_ysk_21
  v_add3_u32 v44, v8, v9, v10
  v_sub_u32 v44, v11, v44
  v_xor_b32 v44, v3, v44
  s_nop 1
  v_or_b32_dpp v44, v44, v44 quad_perm:[1,0,3,2] row_mask:0xf bank_mask:0xf
  s_nop 1
  v_or_b32_dpp v44, v44, v44 quad_perm:[2,3,0,1] row_mask:0xf bank_mask:0xf
  v_cmp_ne_u32 vcc, 0, v44
  s_cbranch_vccnz L_ypd_22
  s_bitset1_b32 s62, 0
  s_branch L_ysk_21
L_ypd_22:
  s_mov_b64 exec, vcc
  buffer_load_dwordx4 v[8:11], v1, s[44:47], s64 offen sc1
  s_mov_b64 exec, -1
L_ysk_21:
  s_bitcmp1_b32 s62, 1
  s_cbranch_scc1 L_ysk_23
  v_add3_u32 v44, v12, v13, v14
  v_sub_u32 v44, v15, v44
  v_xor_b32 v44, v3, v44
  s_nop 1
  v_or_b32_dpp v44, v44, v44 quad_perm:[1,0,3,2] row_mask:0xf bank_mask:0xf
  s_nop 1
  v_or_b32_dpp v44, v44, v44 quad_perm:[2,3,0,1] row_mask:0xf bank_mask:0xf
  v_cmp_ne_u32 vcc, 0, v44
  s_cbranch_vccnz L_ypd_24
  s_bitset1_b32 s62, 1
  s_branch L_ysk_23
L_ypd_24:
  s_mov_b64 exec, vcc
  buffer_load_dwordx4 v[12:15], v1, s[44:47], s65 offen sc1
  s_mov_b64 exec, -1
L_ysk_23:
  s_bitcmp1_b32 s62, 2
  s_cbranch_scc1 L_ysk_25
  v_add3_u32 v44, v16, v17, v18
  v_sub_u32 v44, v19, v44
  v_xor_b32 v44, v3, v44
  s_nop 1
  v_or_b32_dpp v44, v44, v44 quad_perm:[1,0,3,2] row_mask:0xf bank_mask:0xf
  s_nop 1
  v_or_b32_dpp v44, v44, v44 quad_perm:[2,3,0,1] row_mask:0xf bank_mask:0xf
  v_cmp_ne_u32 vcc, 0, v44
  s_cbranch_vccnz L_ypd_26
  s_bitset1_b32 s62, 2
  s_branch L_ysk_25
L_ypd_26:
  s_mov_b64 exec, vcc
  buffer_load_dwordx4 v[16:19], v1, s[44:47], s66 offen sc1
  s_mov_b64 exec, -1
L_ysk_25:
  s_bitcmp1_b32 s62, 3
  s_cbranch_scc1 L_ysk_27
  v_add3_u32 v44, v20, v21, v22
  v_sub_u32 v44, v23, v44
  v_xor_b32 v44, v3, v44
  s_nop 1
  v_or_b32_dpp v44, v44, v44 quad_perm:[1,0,3,2] row_mask:0xf bank_mask:0xf
  s_nop 1
  v_or_b32_dpp v44, v44, v44 quad_perm:[2,3,0,1] row_mask:0xf bank_mask:0xf
  v_cmp_ne_u32 vcc, 0, v44
  s_cbranch_vccnz L_ypd_28
  s_bitset1_b32 s62, 3
  s_branch L_ysk_27
L_ypd_28:
  s_mov_b64 exec, vcc
  buffer_load_dwordx4 v[20:23], v1, s[44:47], s67 offen sc1
  s_mov_b64 exec, -1
L_ysk_27:
  s_bitcmp1_b32 s62, 4
  s_cbranch_scc1 L_ysk_29
  v_add3_u32 v44, v24, v25, v26
  v_sub_u32 v44, v27, v44
  v_xor_b32 v44, v3, v44
  s_nop 1
  v_or_b32_dpp v44, v44, v44 quad_perm:[1,0,3,2] row_mask:0xf bank_mask:0xf
  s_nop 1
  v_or_b32_dpp v44, v44, v44 quad_perm:[2,3,0,1] row_mask:0xf bank_mask:0xf
  v_cmp_ne_u32 vcc, 0, v44
  s_cbranch_vccnz L_ypd_30
  s_bitset1_b32 s62, 4
  s_branch L_ysk_29
L_ypd_30:
  s_mov_b64 exec, vcc
  buffer_load_dwordx4 v[24:27], v1, s[44:47], s68 offen sc1
  s_mov_b64 exec, -1
L_ysk_29:
  s_bitcmp1_b32 s62, 5
  s_cbranch_scc1 L_ysk_31
  v_add3_u32 v44, v28, v29, v30
  v_sub_u32 v44, v31, v44
  v_xor_b32 v44, v3, v44
  s_nop 1
  v_or_b32_dpp v44, v44, v44 quad_perm:[1,0,3,2] row_mask:0xf bank_mask:0xf
  s_nop 1
  v_or_b32_dpp v44, v44, v44 quad_perm:[2,3,0,1] row_mask:0xf bank_mask:0xf
  v_cmp_ne_u32 vcc, 0, v44
  s_cbranch_vccnz L_ypd_32
  s_bitset1_b32 s62, 5
  s_branch L_ysk_31
L_ypd_32:
  s_mov_b64 exec, vcc
  buffer_load_dwordx4 v[28:31], v1, s[44:47], s69 offen sc1
  s_mov_b64 exec, -1
L_ysk_31:
  s_bitcmp1_b32 s62, 6
  s_cbranch_scc1 L_ysk_33
  v_add3_u32 v44, v32, v33, v34
  v_sub_u32 v44, v35, v44
  v_xor_b32 v44, v3, v44
  s_nop 1
  v_or_b32_dpp v44, v44, v44 quad_perm:[1,0,3,2] row_mask:0xf bank_mask:0xf
  s_nop 1
  v_or_b32_dpp v44, v44, v44 quad_perm:[2,3,0,1] row_mask:0xf bank_mask:0xf
  v_cmp_ne_u32 vcc, 0, v44
  s_cbranch_vccnz L_ypd_34
  s_bitset1_b32 s62, 6
  s_branch L_ysk_33
L_ypd_34:
  s_mov_b64 exec, vcc
  buffer_load_dwordx4 v[32:35], v1, s[44:47], s70 offen sc1
  s_mov_b64 exec, -1
L_ysk_33:
  s_bitcmp1_b32 s62, 7
  s_cbranch_scc1 L_ysk_35
  v_add3_u32 v44, v36, v37, v38
  v_sub_u32 v44, v39, v44
  v_xor_b32 v44, v3, v44
  s_nop 1
  v_or_b32_dpp v44, v44, v44 quad_perm:[1,0,3,2] row_mask:0xf bank_mask:0xf
  s_nop 1
  v_or_b32_dpp v44, v44, v44 quad_perm:[2,3,0,1] row_mask:0xf bank_mask:0xf
  v_cmp_ne_u32 vcc, 0, v44
  s_cbranch_vccnz L_ypd_36
  s_bitset1_b32 s62, 7
  s_branch L_ysk_35
L_ypd_36:
  s_mov_b64 exec, vcc
  buffer_load_dwordx4 v[36:39], v1, s[44:47], s71 offen sc1
  s_mov_b64 exec, -1
L_ysk_35:
  s_cmp_eq_u32 s62, 0xff
  s_cbranch_scc1 L_yok_20
  s_add_u32 s59, s59, 1
  s_cmp_le_u32 s59, 200000
  s_cbranch_scc1 L_ylp_19
  s_waitcnt vmcnt(0)
L_yok_20:
  v_add_f32 v8, v8, v12
  v_add_f32 v9, v9, v13
  v_add_f32 v10, v10, v14
  v_add_f32 v8, v8, v16
  v_add_f32 v9, v9, v17
  v_add_f32 v10, v10, v18
  v_add_f32 v8, v8, v20
  v_add_f32 v9, v9, v21
  v_add_f32 v10, v10, v22
  v_add_f32 v8, v8, v24
  v_add_f32 v9, v9, v25
  v_add_f32 v10, v10, v26
  v_add_f32 v8, v8, v28
  v_add_f32 v9, v9, v29
  v_add_f32 v10, v10, v30
  v_add_f32 v8, v8, v32
  v_add_f32 v9, v9, v33
  v_add_f32 v10, v10, v34
  v_add_f32 v8, v8, v36
  v_add_f32 v9, v9, v37
  v_add_f32 v10, v10, v38
  v_mov_b32 v11, 0
  s_nop 1
  v_add_f32_dpp v8, v8, v8 row_ror:4 row_mask:0xf bank_mask:0xf
  v_add_f32_dpp v9, v9, v9 row_ror:4 row_mask:0xf bank_mask:0xf
  v_add_f32_dpp v10, v10, v10 row_ror:4 row_mask:0xf bank_mask:0xf
  s_nop 1
  v_add_f32_dpp v8, v8, v8 row_ror:8 row_mask:0xf bank_mask:0xf
  v_add_f32_dpp v9, v9, v9 row_ror:8 row_mask:0xf bank_mask:0xf
  v_add_f32_dpp v10, v10, v10 row_ror:8 row_mask:0xf bank_mask:0xf
  s_nop 1
  v_permlane16_swap_b32 v8, v9
  v_permlane16_swap_b32 v10, v11
  s_nop 1
  v_add_f32 v8, v8, v9
  v_add_f32 v10, v10, v11
  s_nop 1
  v_permlane32_swap_b32 v8, v10
  s_nop 1
  v_add_f32 v8, v8, v10
  v_add_f32 v8, v7, v8
  v_cvt_pk_bf16_f32 v8, v8, v8
  s_mov_b32 exec_lo, 0x000f000f
  s_mov_b32 exec_hi, 0x0000000f
  global_store_short v6, v8, s[22:23]
  s_mov_b64 exec, -1
L_end:
  s_endpgm
.section .rodata,"a"
.p2align 6
.amdhsa_kernel parallel_sum__mha_block_cached__geglu_ffn__decode_kernel
  .amdhsa_next_free_vgpr 168
  .amdhsa_next_free_sgpr 90
  .amdhsa_accum_offset 168
  .amdhsa_group_segment_fixed_size 0
  .amdhsa_kernarg_size 96
  .amdhsa_user_sgpr_count 2
  .amdhsa_user_sgpr_kernarg_segment_ptr 1
  .amdhsa_system_sgpr_workgroup_id_x 1
  .amdhsa_float_denorm_mode_32 3
.end_amdhsa_kernel
```
